```python
import torch

def _softmax(x, axis=-1):
    return torch.softmax(x, dim=axis)
def _gelu(x):
    return torch.nn.functional.gelu(x, approximate="tanh")
def _silu(x):
    return torch.nn.functional.silu(x)
def _sigmoid(x):
    return torch.sigmoid(x)
def _layernorm(x, axis=-1, eps=1e-5):
    m = x.mean(dim=axis, keepdim=True)
    v = x.var(dim=axis, keepdim=True, unbiased=False)
    return (x - m) / torch.sqrt(v + eps)
def _scatter_add(tgt, idx, src, axis=0):
    return tgt.clone().index_add_(axis, idx, src)
def _segment_sum(src, seg, n):
    out = torch.zeros((n,) + src.shape[1:], dtype=src.dtype)
    return out.index_add_(0, seg, src)
def _pad(x, pw):
    flat = tuple(v for pair in reversed(pw) for v in pair)
    return torch.nn.functional.pad(x, flat)

kernel_name = 'concat_heads__gqa_block_cached__gqa_block_cached__decode'

def setup_inputs():

    _w = (lambda a: (lambda t: t.to(torch.bfloat16) if t.is_floating_point() else t)(torch.as_tensor(a)))
    def _A_setup():
        B, Sq, D = 2, 1, 576
        Hq, Hkv, Sk, Dh = 32, 16, 4096, 128
        assert Hq % Hkv == 0, (Hq, Hkv)
        return {
            "x": _w((lambda *s: torch.randn(*s, dtype=torch.bfloat16) * 0.8)(B, Sq, D)),
            "k_cache": _w((lambda *s: torch.randn(*s, dtype=torch.bfloat16) * 0.8)(B, Hkv, Sk, Dh)),
            "v_cache": _w((lambda *s: torch.randn(*s, dtype=torch.bfloat16) * 0.05)(B, Hkv, Sk, Dh)),
            "wq": _w((lambda *s: torch.randn(*s, dtype=torch.bfloat16) * 0.8)(D, Hq * Dh) * (D ** -0.5)),
            "wo": _w((lambda *s: torch.randn(*s, dtype=torch.bfloat16) * 0.05)(Hq * Dh, D) * ((Hq * Dh) ** -0.5)),
        }
    _A_in = _A_setup()

    def _B_setup():
        B, Sq, D = 2, 1, 576
        Hq, Hkv, Sk, Dh = 32, 16, 4096, 128
        assert Hq % Hkv == 0, (Hq, Hkv)
        return {
            "x": _w((lambda *s: torch.randn(*s, dtype=torch.bfloat16) * 0.8)(B, Sq, D)),
            "k_cache": _w((lambda *s: torch.randn(*s, dtype=torch.bfloat16) * 0.8)(B, Hkv, Sk, Dh)),
            "v_cache": _w((lambda *s: torch.randn(*s, dtype=torch.bfloat16) * 0.05)(B, Hkv, Sk, Dh)),
            "wq": _w((lambda *s: torch.randn(*s, dtype=torch.bfloat16) * 0.8)(D, Hq * Dh) * (D ** -0.5)),
            "wo": _w((lambda *s: torch.randn(*s, dtype=torch.bfloat16) * 0.05)(Hq * Dh, D) * ((Hq * Dh) ** -0.5)),
        }
    _B_in = _B_setup()

    return {
        "A_x": _A_in["x"],
        "A_k_cache": _A_in["k_cache"],
        "A_v_cache": _A_in["v_cache"],
        "A_wq": _A_in["wq"],
        "A_wo": _A_in["wo"],
        "B_x": _B_in["x"],
        "B_k_cache": _B_in["k_cache"],
        "B_v_cache": _B_in["v_cache"],
        "B_wq": _B_in["wq"],
        "B_wo": _B_in["wo"],
    }

def reference(A_x, A_k_cache, A_v_cache, A_wq, A_wo, B_x, B_k_cache, B_v_cache, B_wq, B_wo):
    def _A_ref(x, k_cache, v_cache, wq, wo):
        B, Sq, D = x.shape
        Hq, Dh = 32, 128
        Hkv = k_cache.shape[1]
        rep = Hq // Hkv
        q = (lambda x, *d: x.permute(*d))((x @ wq).reshape(B, Sq, Hq, Dh), 0, 2, 1, 3)
        k = (lambda x, n, axis: torch.repeat_interleave(x, n, dim=axis))(k_cache, rep, axis=1)
        v = (lambda x, n, axis: torch.repeat_interleave(x, n, dim=axis))(v_cache, rep, axis=1)
        scores = torch.einsum("bhqd,bhkd->bhqk", q, k) * (Dh ** -0.5)
        p = _softmax(scores, axis=-1)
        o = torch.einsum("bhqk,bhkd->bhqd", p, v)
        return (lambda x, *d: x.permute(*d))(o, 0, 2, 1, 3).reshape(B, Sq, Hq * Dh) @ wo

    def _B_ref(x, k_cache, v_cache, wq, wo):
        B, Sq, D = x.shape
        Hq, Dh = 32, 128
        Hkv = k_cache.shape[1]
        rep = Hq // Hkv
        q = (lambda x, *d: x.permute(*d))((x @ wq).reshape(B, Sq, Hq, Dh), 0, 2, 1, 3)
        k = (lambda x, n, axis: torch.repeat_interleave(x, n, dim=axis))(k_cache, rep, axis=1)
        v = (lambda x, n, axis: torch.repeat_interleave(x, n, dim=axis))(v_cache, rep, axis=1)
        scores = torch.einsum("bhqd,bhkd->bhqk", q, k) * (Dh ** -0.5)
        p = _softmax(scores, axis=-1)
        o = torch.einsum("bhqk,bhkd->bhqd", p, v)
        return (lambda x, *d: x.permute(*d))(o, 0, 2, 1, 3).reshape(B, Sq, Hq * Dh) @ wo

    a = _A_ref(A_x, A_k_cache, A_v_cache, A_wq, A_wo)
    b = _B_ref(B_x, B_k_cache, B_v_cache, B_wq, B_wo)
    return torch.concatenate([a, b], axis=-1)
```

```asm
; @launch grid=(256,1,1) block=(640,1,1) lds=140352
.amdgcn_target "amdgcn-amd-amdhsa--gfx950"
.text
.globl concat_heads__gqa_block_cached__gqa_block_cached__decode_kernel
.p2align 8
.type concat_heads__gqa_block_cached__gqa_block_cached__decode_kernel,@function
concat_heads__gqa_block_cached__gqa_block_cached__decode_kernel:
    s_load_dwordx16 s[4:19], s[0:1], 0
    s_load_dwordx8 s[20:27], s[0:1], 64
    s_load_dwordx2 s[28:29], s[0:1], 96
    s_cmp_ge_u32 s2, 256
    s_cbranch_scc1 L_end
    v_lshrrev_b32 v1, 6, v0
    v_and_b32 v0, 63, v0
    s_lshr_b32 s32, s2, 7
    v_readfirstlane_b32 s36, v1
    s_and_b32 s33, s2, 7
    s_bfe_u32 s37, s2, 0x10006
    s_lshl_b32 s37, s37, 3
    s_or_b32 s33, s33, s37
    s_bfe_u32 s31, s2, 0x30003
    s_lshl_b32 s30, s32, 4
    s_or_b32 s30, s30, s33
    s_bfe_u32 s34, s2, 0x10005
    s_bfe_u32 s35, s2, 0x20003
    s_cmp_ge_u32 s36, 4
    s_cbranch_scc1 L_hi
    v_lshrrev_b32 v3, 3, v0
    v_and_b32 v4, 7, v0
    v_lshlrev_b32 v6, 13, v3
    v_lshl_add_u32 v6, v4, 4, v6
    s_mul_i32 s37, s31, 589824
    s_lshl_b32 s38, s33, 9
    s_add_u32 s37, s37, s38
    s_lshl_b32 s38, s36, 7
    s_add_u32 s37, s37, s38
    s_mov_b32 s58, 4718592
    s_mov_b32 s59, 0x20000
    s_cmp_eq_u32 s32, 0
    s_waitcnt lgkmcnt(0)
    s_cselect_b64 s[56:57], s[10:11], s[20:21]
    s_cselect_b64 s[52:53], s[4:5], s[14:15]
    buffer_load_dwordx4 v[28:31], v6, s[56:59], s37 offen nt
    s_add_u32 s37, s37, 65536
    buffer_load_dwordx4 v[32:35], v6, s[56:59], s37 offen nt
    s_add_u32 s37, s37, 65536
    buffer_load_dwordx4 v[36:39], v6, s[56:59], s37 offen nt
    s_add_u32 s37, s37, 65536
    buffer_load_dwordx4 v[40:43], v6, s[56:59], s37 offen nt
    s_add_u32 s37, s37, 65536
    buffer_load_dwordx4 v[44:47], v6, s[56:59], s37 offen nt
    s_add_u32 s37, s37, 65536
    buffer_load_dwordx4 v[48:51], v6, s[56:59], s37 offen nt
    s_add_u32 s37, s37, 65536
    buffer_load_dwordx4 v[52:55], v6, s[56:59], s37 offen nt
    s_add_u32 s37, s37, 65536
    buffer_load_dwordx4 v[56:59], v6, s[56:59], s37 offen nt
    s_add_u32 s37, s37, 65536
    buffer_load_dwordx4 v[60:63], v6, s[56:59], s37 offen nt
    s_mov_b32 s54, 2304
    s_mov_b32 s55, 0x20000
    v_lshlrev_b32 v5, 4, v0
    v_cmp_lt_u32 vcc, 8, v0
    v_add_u32 v7, 1008, v5
    s_lshl_b32 s37, s36, 9
    s_add_u32 m0, s37, 138240
    v_cndmask_b32 v5, v5, v7, vcc
    s_mul_i32 s38, s31, 144
    s_mov_b64 exec, 0x3ffff
    buffer_load_dwordx4 v5, s[52:55], s38 offen lds
    s_mov_b64 exec, -1
    s_waitcnt vmcnt(9)
    s_barrier
    s_add_u32 s37, s37, 138240
    v_lshl_add_u32 v5, v3, 1, s37
    s_lshl_b32 s38, s32, 8
    s_load_dword s39, s[28:29], s38
    s_mov_b32 s48, s28
    s_mov_b32 s49, s29
    s_mov_b32 s50, 4194304
    s_mov_b32 s51, 0x20000
    v_lshrrev_b32 v1, 4, v0
    v_and_b32 v2, 15, v0
    v_mov_b32 v81, 140288
    s_mov_b32 s10, 0xff
    v_mov_b32 v8, 0
    v_mov_b32 v9, 0
    v_mov_b32 v10, 0
    v_mov_b32 v11, 0
    v_mov_b32 v12, 0
    v_mov_b32 v13, 0
    v_mov_b32 v14, 0
    v_mov_b32 v15, 0
    v_mov_b32 v16, 0
    v_mov_b32 v17, 0
    v_mov_b32 v18, 0
    v_mov_b32 v19, 0
    v_mov_b32 v20, 0
    v_mov_b32 v21, 0
    v_mov_b32 v22, 0
    v_mov_b32 v23, 0
    v_mov_b32 v24, 0
    v_mov_b32 v25, 0
    v_mov_b32 v64, 0
    v_mov_b32 v65, 0
    v_mov_b32 v66, 0
    v_mov_b32 v67, 0
    v_mov_b32 v68, 0
    v_mov_b32 v69, 0
    v_mov_b32 v70, 0
    v_mov_b32 v71, 0
    v_mov_b32 v72, 0
    v_mov_b32 v73, 0
    v_mov_b32 v74, 0
    v_mov_b32 v75, 0
    v_mov_b32 v76, 0
    v_mov_b32 v77, 0
    v_mov_b32 v78, 0
    v_mov_b32 v79, 0
    s_waitcnt vmcnt(0) lgkmcnt(0)
L_w0:
    s_cbranch_execz L_w1
    ds_read_u16_d16_hi v8, v5 offset:0
    ds_read_u16_d16_hi v9, v5 offset:144
    ds_read_u16_d16_hi v10, v5 offset:16
    ds_read_u16_d16_hi v11, v5 offset:160
    ds_read_u16_d16_hi v12, v5 offset:32
    ds_read_u16_d16_hi v13, v5 offset:176
    ds_read_u16_d16_hi v14, v5 offset:48
L_w1:
    s_cbranch_execz L_w2
    ds_read_u16_d16_hi v15, v5 offset:192
    ds_read_u16_d16_hi v16, v5 offset:64
    ds_read_u16_d16_hi v17, v5 offset:208
    ds_read_u16_d16_hi v18, v5 offset:80
    ds_read_u16_d16_hi v19, v5 offset:224
    ds_read_u16_d16_hi v20, v5 offset:96
    ds_read_u16_d16_hi v21, v5 offset:240
L_w2:
    s_cbranch_execz L_w3
    ds_read_u16_d16_hi v22, v5 offset:112
    ds_read_u16_d16_hi v23, v5 offset:256
    ds_read_u16_d16_hi v24, v5 offset:128
    ds_read_u16_d16_hi v25, v5 offset:272
    s_add_u32 s39, s39, 1
    s_and_b32 s3, s39, 0xff
    s_bfe_u32 s77, s39, 0x80008
L_w3:
    s_cbranch_execz L_w4
    s_bfe_u32 s78, s39, 0x80010
    s_lshr_b32 s79, s39, 24
    v_mov_b32 v80, s3
    v_mov_b32 v148, s77
    v_mov_b32 v149, s78
    v_mov_b32 v150, s79
    s_getreg_b32 s21, hwreg(HW_REG_XCC_ID)
    s_and_b32 s21, s21, 7
    s_lshl_b32 s21, s21, 5
    s_add_u32 s21, s21, s39
    s_lshl_b32 s85, s21, 8
    s_and_b32 s21, s21, 0xff
L_w4:
    s_cbranch_execz L_w5
    s_waitcnt lgkmcnt(15)
    v_lshlrev_b32 v82, 16, v28
    v_and_b32 v83, 0xffff0000, v28
    v_pk_fma_f32 v[64:65], v[8:9], v[82:83], v[64:65] op_sel:[0,0,0] op_sel_hi:[1,0,1]
    v_pk_fma_f32 v[66:67], v[8:9], v[82:83], v[66:67] op_sel:[0,1,0] op_sel_hi:[1,1,1]
    v_lshlrev_b32 v82, 16, v29
    v_and_b32 v83, 0xffff0000, v29
    v_pk_fma_f32 v[68:69], v[8:9], v[82:83], v[68:69] op_sel:[0,0,0] op_sel_hi:[1,0,1]
L_w5:
    s_cbranch_execz L_w6
    v_pk_fma_f32 v[70:71], v[8:9], v[82:83], v[70:71] op_sel:[0,1,0] op_sel_hi:[1,1,1]
    v_lshlrev_b32 v82, 16, v30
    v_and_b32 v83, 0xffff0000, v30
    v_pk_fma_f32 v[72:73], v[8:9], v[82:83], v[72:73] op_sel:[0,0,0] op_sel_hi:[1,0,1]
    v_pk_fma_f32 v[74:75], v[8:9], v[82:83], v[74:75] op_sel:[0,1,0] op_sel_hi:[1,1,1]
    v_lshlrev_b32 v82, 16, v31
    v_and_b32 v83, 0xffff0000, v31
    v_pk_fma_f32 v[76:77], v[8:9], v[82:83], v[76:77] op_sel:[0,0,0] op_sel_hi:[1,0,1]
L_w6:
    s_cbranch_execz L_w7
    v_pk_fma_f32 v[78:79], v[8:9], v[82:83], v[78:79] op_sel:[0,1,0] op_sel_hi:[1,1,1]
    s_waitcnt lgkmcnt(14)
    v_lshlrev_b32 v82, 16, v32
    v_and_b32 v83, 0xffff0000, v32
    v_pk_fma_f32 v[64:65], v[10:11], v[82:83], v[64:65] op_sel:[0,0,0] op_sel_hi:[1,0,1]
    v_pk_fma_f32 v[66:67], v[10:11], v[82:83], v[66:67] op_sel:[0,1,0] op_sel_hi:[1,1,1]
    v_lshlrev_b32 v82, 16, v33
    v_and_b32 v83, 0xffff0000, v33
L_w7:
    s_cbranch_execz L_w8
    v_pk_fma_f32 v[68:69], v[10:11], v[82:83], v[68:69] op_sel:[0,0,0] op_sel_hi:[1,0,1]
    v_pk_fma_f32 v[70:71], v[10:11], v[82:83], v[70:71] op_sel:[0,1,0] op_sel_hi:[1,1,1]
    v_lshlrev_b32 v82, 16, v34
    v_and_b32 v83, 0xffff0000, v34
    v_pk_fma_f32 v[72:73], v[10:11], v[82:83], v[72:73] op_sel:[0,0,0] op_sel_hi:[1,0,1]
    v_pk_fma_f32 v[74:75], v[10:11], v[82:83], v[74:75] op_sel:[0,1,0] op_sel_hi:[1,1,1]
    v_lshlrev_b32 v82, 16, v35
    v_and_b32 v83, 0xffff0000, v35
L_w8:
    s_cbranch_execz L_w9
    v_pk_fma_f32 v[76:77], v[10:11], v[82:83], v[76:77] op_sel:[0,0,0] op_sel_hi:[1,0,1]
    v_pk_fma_f32 v[78:79], v[10:11], v[82:83], v[78:79] op_sel:[0,1,0] op_sel_hi:[1,1,1]
    s_waitcnt lgkmcnt(12)
    v_lshlrev_b32 v82, 16, v36
    v_and_b32 v83, 0xffff0000, v36
    v_pk_fma_f32 v[64:65], v[12:13], v[82:83], v[64:65] op_sel:[0,0,0] op_sel_hi:[1,0,1]
    v_pk_fma_f32 v[66:67], v[12:13], v[82:83], v[66:67] op_sel:[0,1,0] op_sel_hi:[1,1,1]
    v_lshlrev_b32 v82, 16, v37
L_w9:
    s_cbranch_execz L_w10
    v_and_b32 v83, 0xffff0000, v37
    v_pk_fma_f32 v[68:69], v[12:13], v[82:83], v[68:69] op_sel:[0,0,0] op_sel_hi:[1,0,1]
    v_pk_fma_f32 v[70:71], v[12:13], v[82:83], v[70:71] op_sel:[0,1,0] op_sel_hi:[1,1,1]
    v_lshlrev_b32 v82, 16, v38
    v_and_b32 v83, 0xffff0000, v38
    v_pk_fma_f32 v[72:73], v[12:13], v[82:83], v[72:73] op_sel:[0,0,0] op_sel_hi:[1,0,1]
    v_pk_fma_f32 v[74:75], v[12:13], v[82:83], v[74:75] op_sel:[0,1,0] op_sel_hi:[1,1,1]
    v_lshlrev_b32 v82, 16, v39
L_w10:
    s_cbranch_execz L_w11
    v_and_b32 v83, 0xffff0000, v39
    v_pk_fma_f32 v[76:77], v[12:13], v[82:83], v[76:77] op_sel:[0,0,0] op_sel_hi:[1,0,1]
    v_pk_fma_f32 v[78:79], v[12:13], v[82:83], v[78:79] op_sel:[0,1,0] op_sel_hi:[1,1,1]
    s_waitcnt lgkmcnt(10)
    v_lshlrev_b32 v82, 16, v40
    v_and_b32 v83, 0xffff0000, v40
    v_pk_fma_f32 v[64:65], v[14:15], v[82:83], v[64:65] op_sel:[0,0,0] op_sel_hi:[1,0,1]
    v_pk_fma_f32 v[66:67], v[14:15], v[82:83], v[66:67] op_sel:[0,1,0] op_sel_hi:[1,1,1]
L_w11:
    s_cbranch_execz L_w12
    v_lshlrev_b32 v82, 16, v41
    v_and_b32 v83, 0xffff0000, v41
    v_pk_fma_f32 v[68:69], v[14:15], v[82:83], v[68:69] op_sel:[0,0,0] op_sel_hi:[1,0,1]
    v_pk_fma_f32 v[70:71], v[14:15], v[82:83], v[70:71] op_sel:[0,1,0] op_sel_hi:[1,1,1]
    v_lshlrev_b32 v82, 16, v42
    v_and_b32 v83, 0xffff0000, v42
    v_pk_fma_f32 v[72:73], v[14:15], v[82:83], v[72:73] op_sel:[0,0,0] op_sel_hi:[1,0,1]
    v_pk_fma_f32 v[74:75], v[14:15], v[82:83], v[74:75] op_sel:[0,1,0] op_sel_hi:[1,1,1]
L_w12:
    s_cbranch_execz L_w13
    v_lshlrev_b32 v82, 16, v43
    v_and_b32 v83, 0xffff0000, v43
    v_pk_fma_f32 v[76:77], v[14:15], v[82:83], v[76:77] op_sel:[0,0,0] op_sel_hi:[1,0,1]
    v_pk_fma_f32 v[78:79], v[14:15], v[82:83], v[78:79] op_sel:[0,1,0] op_sel_hi:[1,1,1]
    s_waitcnt lgkmcnt(8)
    v_lshlrev_b32 v82, 16, v44
    v_and_b32 v83, 0xffff0000, v44
    v_pk_fma_f32 v[64:65], v[16:17], v[82:83], v[64:65] op_sel:[0,0,0] op_sel_hi:[1,0,1]
L_w13:
    s_cbranch_execz L_w14
    v_pk_fma_f32 v[66:67], v[16:17], v[82:83], v[66:67] op_sel:[0,1,0] op_sel_hi:[1,1,1]
    v_lshlrev_b32 v82, 16, v45
    v_and_b32 v83, 0xffff0000, v45
    v_pk_fma_f32 v[68:69], v[16:17], v[82:83], v[68:69] op_sel:[0,0,0] op_sel_hi:[1,0,1]
    v_pk_fma_f32 v[70:71], v[16:17], v[82:83], v[70:71] op_sel:[0,1,0] op_sel_hi:[1,1,1]
    v_lshlrev_b32 v82, 16, v46
    v_and_b32 v83, 0xffff0000, v46
    v_pk_fma_f32 v[72:73], v[16:17], v[82:83], v[72:73] op_sel:[0,0,0] op_sel_hi:[1,0,1]
L_w14:
    s_cbranch_execz L_w15
    v_pk_fma_f32 v[74:75], v[16:17], v[82:83], v[74:75] op_sel:[0,1,0] op_sel_hi:[1,1,1]
    v_lshlrev_b32 v82, 16, v47
    v_and_b32 v83, 0xffff0000, v47
    v_pk_fma_f32 v[76:77], v[16:17], v[82:83], v[76:77] op_sel:[0,0,0] op_sel_hi:[1,0,1]
    v_pk_fma_f32 v[78:79], v[16:17], v[82:83], v[78:79] op_sel:[0,1,0] op_sel_hi:[1,1,1]
    s_waitcnt lgkmcnt(6)
    v_lshlrev_b32 v82, 16, v48
    v_and_b32 v83, 0xffff0000, v48
L_w15:
    s_cbranch_execz L_w16
    v_pk_fma_f32 v[64:65], v[18:19], v[82:83], v[64:65] op_sel:[0,0,0] op_sel_hi:[1,0,1]
    v_pk_fma_f32 v[66:67], v[18:19], v[82:83], v[66:67] op_sel:[0,1,0] op_sel_hi:[1,1,1]
    v_lshlrev_b32 v82, 16, v49
    v_and_b32 v83, 0xffff0000, v49
    v_pk_fma_f32 v[68:69], v[18:19], v[82:83], v[68:69] op_sel:[0,0,0] op_sel_hi:[1,0,1]
    v_pk_fma_f32 v[70:71], v[18:19], v[82:83], v[70:71] op_sel:[0,1,0] op_sel_hi:[1,1,1]
    v_lshlrev_b32 v82, 16, v50
    v_and_b32 v83, 0xffff0000, v50
L_w16:
    s_cbranch_execz L_w17
    v_pk_fma_f32 v[72:73], v[18:19], v[82:83], v[72:73] op_sel:[0,0,0] op_sel_hi:[1,0,1]
    v_pk_fma_f32 v[74:75], v[18:19], v[82:83], v[74:75] op_sel:[0,1,0] op_sel_hi:[1,1,1]
    v_lshlrev_b32 v82, 16, v51
    v_and_b32 v83, 0xffff0000, v51
    v_pk_fma_f32 v[76:77], v[18:19], v[82:83], v[76:77] op_sel:[0,0,0] op_sel_hi:[1,0,1]
    v_pk_fma_f32 v[78:79], v[18:19], v[82:83], v[78:79] op_sel:[0,1,0] op_sel_hi:[1,1,1]
    s_waitcnt lgkmcnt(4)
    v_lshlrev_b32 v82, 16, v52
L_w17:
    s_cbranch_execz L_w18
    v_and_b32 v83, 0xffff0000, v52
    v_pk_fma_f32 v[64:65], v[20:21], v[82:83], v[64:65] op_sel:[0,0,0] op_sel_hi:[1,0,1]
    v_pk_fma_f32 v[66:67], v[20:21], v[82:83], v[66:67] op_sel:[0,1,0] op_sel_hi:[1,1,1]
    v_lshlrev_b32 v82, 16, v53
    v_and_b32 v83, 0xffff0000, v53
    v_pk_fma_f32 v[68:69], v[20:21], v[82:83], v[68:69] op_sel:[0,0,0] op_sel_hi:[1,0,1]
    v_pk_fma_f32 v[70:71], v[20:21], v[82:83], v[70:71] op_sel:[0,1,0] op_sel_hi:[1,1,1]
    v_lshlrev_b32 v82, 16, v54
L_w18:
    s_cbranch_execz L_w19
    v_and_b32 v83, 0xffff0000, v54
    v_pk_fma_f32 v[72:73], v[20:21], v[82:83], v[72:73] op_sel:[0,0,0] op_sel_hi:[1,0,1]
    v_pk_fma_f32 v[74:75], v[20:21], v[82:83], v[74:75] op_sel:[0,1,0] op_sel_hi:[1,1,1]
    v_lshlrev_b32 v82, 16, v55
    v_and_b32 v83, 0xffff0000, v55
    v_pk_fma_f32 v[76:77], v[20:21], v[82:83], v[76:77] op_sel:[0,0,0] op_sel_hi:[1,0,1]
    v_pk_fma_f32 v[78:79], v[20:21], v[82:83], v[78:79] op_sel:[0,1,0] op_sel_hi:[1,1,1]
    s_waitcnt lgkmcnt(2)
L_w19:
    s_cbranch_execz L_w20
    v_lshlrev_b32 v82, 16, v56
    v_and_b32 v83, 0xffff0000, v56
    v_pk_fma_f32 v[64:65], v[22:23], v[82:83], v[64:65] op_sel:[0,0,0] op_sel_hi:[1,0,1]
    v_pk_fma_f32 v[66:67], v[22:23], v[82:83], v[66:67] op_sel:[0,1,0] op_sel_hi:[1,1,1]
    v_lshlrev_b32 v82, 16, v57
    v_and_b32 v83, 0xffff0000, v57
    v_pk_fma_f32 v[68:69], v[22:23], v[82:83], v[68:69] op_sel:[0,0,0] op_sel_hi:[1,0,1]
    v_pk_fma_f32 v[70:71], v[22:23], v[82:83], v[70:71] op_sel:[0,1,0] op_sel_hi:[1,1,1]
L_w20:
    s_cbranch_execz L_w21
    v_lshlrev_b32 v82, 16, v58
    v_and_b32 v83, 0xffff0000, v58
    v_pk_fma_f32 v[72:73], v[22:23], v[82:83], v[72:73] op_sel:[0,0,0] op_sel_hi:[1,0,1]
    v_pk_fma_f32 v[74:75], v[22:23], v[82:83], v[74:75] op_sel:[0,1,0] op_sel_hi:[1,1,1]
    v_lshlrev_b32 v82, 16, v59
    v_and_b32 v83, 0xffff0000, v59
    v_pk_fma_f32 v[76:77], v[22:23], v[82:83], v[76:77] op_sel:[0,0,0] op_sel_hi:[1,0,1]
    v_pk_fma_f32 v[78:79], v[22:23], v[82:83], v[78:79] op_sel:[0,1,0] op_sel_hi:[1,1,1]
L_w21:
    s_cbranch_execz L_w22
    s_waitcnt lgkmcnt(0)
    v_lshlrev_b32 v82, 16, v60
    v_and_b32 v83, 0xffff0000, v60
    v_pk_fma_f32 v[64:65], v[24:25], v[82:83], v[64:65] op_sel:[0,0,0] op_sel_hi:[1,0,1]
    v_pk_fma_f32 v[66:67], v[24:25], v[82:83], v[66:67] op_sel:[0,1,0] op_sel_hi:[1,1,1]
    v_lshlrev_b32 v82, 16, v61
    v_and_b32 v83, 0xffff0000, v61
    v_pk_fma_f32 v[68:69], v[24:25], v[82:83], v[68:69] op_sel:[0,0,0] op_sel_hi:[1,0,1]
L_w22:
    s_cbranch_execz L_w23
    v_pk_fma_f32 v[70:71], v[24:25], v[82:83], v[70:71] op_sel:[0,1,0] op_sel_hi:[1,1,1]
    v_lshlrev_b32 v82, 16, v62
    v_and_b32 v83, 0xffff0000, v62
    v_pk_fma_f32 v[72:73], v[24:25], v[82:83], v[72:73] op_sel:[0,0,0] op_sel_hi:[1,0,1]
    v_pk_fma_f32 v[74:75], v[24:25], v[82:83], v[74:75] op_sel:[0,1,0] op_sel_hi:[1,1,1]
    v_lshlrev_b32 v82, 16, v63
    v_and_b32 v83, 0xffff0000, v63
    v_pk_fma_f32 v[76:77], v[24:25], v[82:83], v[76:77] op_sel:[0,0,0] op_sel_hi:[1,0,1]
L_w23:
    s_cbranch_execz L_w24
    v_pk_fma_f32 v[78:79], v[24:25], v[82:83], v[78:79] op_sel:[0,1,0] op_sel_hi:[1,1,1]
    s_lshl_b32 s37, s30, 3
    s_add_u32 s37, s37, s31
    s_lshl_b32 s37, s37, 11
    s_lshl_b32 s38, s36, 8
    s_add_u32 s37, s37, s38
    v_permlane32_swap_b32 v64, v65
    v_permlane32_swap_b32 v66, v67
    v_permlane32_swap_b32 v68, v69
    v_permlane32_swap_b32 v70, v71
    v_permlane32_swap_b32 v72, v73
    v_permlane32_swap_b32 v74, v75
    v_permlane32_swap_b32 v76, v77
L_w24:
    s_cbranch_execz L_w25
    v_permlane32_swap_b32 v78, v79
    v_add_f32 v64, v64, v65
    v_add_f32 v66, v66, v67
    v_add_f32 v68, v68, v69
    v_add_f32 v70, v70, v71
    v_add_f32 v72, v72, v73
    v_add_f32 v74, v74, v75
    v_add_f32 v76, v76, v77
    v_add_f32 v78, v78, v79
    s_add_u32 s70, s37, 65536
    s_add_u32 s37, s70, 2097152
    v_permlane16_swap_b32 v64, v72
L_w25:
    s_cbranch_execz L_w26
    v_permlane16_swap_b32 v66, v74
    v_permlane16_swap_b32 v68, v76
    v_permlane16_swap_b32 v70, v78
    v_add_f32 v64, v64, v72
    v_add_f32 v66, v66, v74
    v_add_f32 v68, v68, v76
    v_add_f32 v70, v70, v78
    v_lshrrev_b32 v5, 5, v0
    v_lshlrev_b32 v5, 10, v5
    v_lshl_add_u32 v5, v4, 5, v5
    v_and_b32 v6, 1, v1
    v_lshl_add_u32 v5, v6, 4, v5
L_w26:
    s_cbranch_execz L_w27
    v_add_f32_dpp v72, v64, v64 row_ror:8 row_mask:0xf bank_mask:0xf
    v_add_f32_dpp v73, v66, v66 row_ror:8 row_mask:0xf bank_mask:0xf
    v_add_f32_dpp v74, v68, v68 row_ror:8 row_mask:0xf bank_mask:0xf
    v_add_f32_dpp v75, v70, v70 row_ror:8 row_mask:0xf bank_mask:0xf
    v_mov_b32 v76, s21
    v_bfi_b32 v64, s10, v76, v72
    v_bfi_b32 v65, s10, v148, v73
L_w27:
    s_cbranch_execz L_w28
    v_bfi_b32 v66, s10, v149, v74
    v_bfi_b32 v67, s10, v150, v75
    s_mov_b32 exec_lo, 0x00ff00ff
    s_mov_b32 exec_hi, 0x00ff00ff
    buffer_store_dwordx4 v[64:67], v5, s[48:51], s37 offen
    s_mov_b64 exec, -1
    s_cmp_eq_u32 s36, 0
    s_cbranch_scc0 L_cset
    s_lshl_b32 s16, s30, 14
L_w28:
    s_cbranch_execz L_w29
    s_lshl_b32 s38, s34, 10
    s_add_u32 s16, s16, s38
    s_add_u32 s16, s16, 2162688
    v_lshlrev_b32 v8, 4, v0
    s_mov_b32 s71, s21
    s_mov_b32 s68, 0
    s_mov_b32 s69, 0
    v_mov_b32 v7, 1
    v_add_u32 v9, 4096, v8
    v_add_u32 v10, 8192, v8
L_w29:
    s_cbranch_execz L_w30
    v_add_u32 v11, 12288, v8
    s_waitcnt vmcnt(0)
    s_mov_b32 s9, 2097151
L_pq:
    buffer_load_dwordx4 v[16:19], v8, s[48:51], s16 offen sc1
    buffer_load_dwordx4 v[20:23], v8, s[48:51], s16 offen offset:2048 sc1
    buffer_load_dwordx4 v[24:27], v9, s[48:51], s16 offen sc1
    buffer_load_dwordx4 v[28:31], v9, s[48:51], s16 offen offset:2048 sc1
L_w30:
    s_cbranch_execz L_w31
    buffer_load_dwordx4 v[32:35], v10, s[48:51], s16 offen sc1
    buffer_load_dwordx4 v[36:39], v10, s[48:51], s16 offen offset:2048 sc1
    buffer_load_dwordx4 v[40:43], v11, s[48:51], s16 offen sc1
    buffer_load_dwordx4 v[44:47], v11, s[48:51], s16 offen offset:2048 sc1
    s_sub_u32 s9, s9, 1
    s_cbranch_scc1 L_pq_d
    s_cmp_eq_u32 s9, 2097145
    s_cbranch_scc1 L_fb
L_pq_k:
    s_waitcnt vmcnt(7)
L_w31:
    s_cbranch_execz L_w32
    v_xor_b32 v16, s71, v16
    v_xor_b32 v17, s77, v17
    v_xor_b32 v18, s78, v18
    v_xor_b32 v19, s79, v19
    v_or3_b32 v6, v16, v17, v18
    v_or_b32 v6, v6, v19
    s_waitcnt vmcnt(6)
    v_xor_b32 v20, s71, v20
    v_xor_b32 v21, s77, v21
    v_xor_b32 v22, s78, v22
    v_xor_b32 v23, s79, v23
    v_or3_b32 v6, v6, v20, v21
L_w32:
    s_cbranch_execz L_w33
    v_or3_b32 v6, v6, v22, v23
    s_waitcnt vmcnt(5)
    v_xor_b32 v24, s71, v24
    v_xor_b32 v25, s77, v25
    v_xor_b32 v26, s78, v26
    v_xor_b32 v27, s79, v27
    v_or3_b32 v6, v6, v24, v25
    v_or3_b32 v6, v6, v26, v27
    s_waitcnt vmcnt(4)
    v_xor_b32 v28, s71, v28
    v_xor_b32 v29, s77, v29
L_w33:
    s_cbranch_execz L_w34
    v_xor_b32 v30, s78, v30
    v_xor_b32 v31, s79, v31
    v_or3_b32 v6, v6, v28, v29
    v_or3_b32 v6, v6, v30, v31
    s_waitcnt vmcnt(3)
    v_xor_b32 v32, s71, v32
    v_xor_b32 v33, s77, v33
    v_xor_b32 v34, s78, v34
    v_xor_b32 v35, s79, v35
    v_or3_b32 v6, v6, v32, v33
L_w34:
    s_cbranch_execz L_w35
    v_or3_b32 v6, v6, v34, v35
    s_waitcnt vmcnt(2)
    v_xor_b32 v36, s71, v36
    v_xor_b32 v37, s77, v37
    v_xor_b32 v38, s78, v38
    v_xor_b32 v39, s79, v39
    v_or3_b32 v6, v6, v36, v37
    v_or3_b32 v6, v6, v38, v39
    s_waitcnt vmcnt(1)
    v_xor_b32 v40, s71, v40
    v_xor_b32 v41, s77, v41
L_w35:
    s_cbranch_execz L_w36
    v_xor_b32 v42, s78, v42
    v_xor_b32 v43, s79, v43
    v_or3_b32 v6, v6, v40, v41
    v_or3_b32 v6, v6, v42, v43
    s_waitcnt vmcnt(0)
    v_xor_b32 v44, s71, v44
    v_xor_b32 v45, s77, v45
    v_xor_b32 v46, s78, v46
    v_xor_b32 v47, s79, v47
    v_or3_b32 v6, v6, v44, v45
L_w36:
    s_cbranch_execz L_w37
    v_or3_b32 v6, v6, v46, v47
    v_and_b32 v6, 0xff, v6
    v_cmp_ne_u32 vcc, 0, v6
    s_xor_b32 s16, s16, s68
    s_xor_b32 s71, s71, s69
    s_cbranch_vccnz L_pq
L_pq_d:
    v_pk_add_f32 v[16:17], v[16:17], v[32:33]
    v_pk_add_f32 v[18:19], v[18:19], v[34:35]
    v_pk_add_f32 v[20:21], v[20:21], v[36:37]
L_w37:
    s_cbranch_execz L_w38
    v_pk_add_f32 v[22:23], v[22:23], v[38:39]
    v_pk_add_f32 v[24:25], v[24:25], v[40:41]
    v_pk_add_f32 v[26:27], v[26:27], v[42:43]
    v_pk_add_f32 v[28:29], v[28:29], v[44:45]
    v_pk_add_f32 v[30:31], v[30:31], v[46:47]
    v_pk_add_f32 v[16:17], v[16:17], v[24:25]
    v_pk_add_f32 v[18:19], v[18:19], v[26:27]
L_w38:
    s_cbranch_execz L_w39
    v_pk_add_f32 v[20:21], v[20:21], v[28:29]
    v_pk_add_f32 v[22:23], v[22:23], v[30:31]
    v_pk_add_f32 v[16:17], v[16:17], v[20:21]
    v_pk_add_f32 v[18:19], v[18:19], v[22:23]
    v_cvt_pk_bf16_f32 v16, v16, v17
    v_cvt_pk_bf16_f32 v17, v18, v19
    v_lshlrev_b32 v6, 3, v0
L_w39:
    s_cbranch_execz L_w40
    v_add_u32 v6, 131072, v6
    ds_write_b64 v6, v[16:17]
    ds_write_b32 v81, v7 offset:4
L_cset:
    s_lshl_b32 s8, s36, 13
    v_xor_b32 v3, v1, v2
    v_lshlrev_b32 v3, 4, v3
    v_lshl_add_u32 v3, v2, 8, v3
    v_add_u32 v10, s8, v3
    v_xor_b32 v11, 64, v10
L_w40:
    s_cbranch_execz L_w41
    v_xor_b32 v12, 0x80, v10
    v_xor_b32 v13, 0xc0, v10
    v_lshrrev_b32 v3, 2, v2
    v_lshl_add_u32 v3, v1, 2, v3
    v_and_b32 v32, 7, v3
    v_lshlrev_b32 v32, 5, v32
    v_lshl_add_u32 v3, v3, 8, v32
    v_and_b32 v32, 3, v2
    v_lshl_add_u32 v3, v32, 3, v3
L_w41:
    s_cbranch_execz L_w42
    v_add_u32 v14, s8, v3
    v_xor_b32 v15, 32, v14
    v_xor_b32 v16, 64, v14
    v_xor_b32 v17, 96, v14
    v_xor_b32 v18, 128, v14
    v_xor_b32 v19, 160, v14
    v_xor_b32 v20, 192, v14
    v_xor_b32 v21, 224, v14
    v_lshrrev_b32 v3, 1, v2
L_w42:
    s_cbranch_execz L_w43
    v_cmp_eq_u32 vcc, 0, v3
    s_nop 1
    v_cndmask_b32 v22, 0, -1, vcc
    v_cmp_eq_u32 vcc, 1, v3
    s_nop 1
    v_cndmask_b32 v23, 0, -1, vcc
    v_cmp_eq_u32 vcc, 2, v3
    s_nop 1
    v_cndmask_b32 v24, 0, -1, vcc
    v_cmp_eq_u32 vcc, 3, v3
    s_nop 1
L_w43:
    s_cbranch_execz L_w44
    v_cndmask_b32 v25, 0, -1, vcc
    v_cmp_eq_u32 vcc, 4, v3
    s_nop 1
    v_cndmask_b32 v26, 0, -1, vcc
    v_cmp_eq_u32 vcc, 5, v3
    s_nop 1
    v_cndmask_b32 v27, 0, -1, vcc
    v_cmp_eq_u32 vcc, 6, v3
    s_nop 1
    v_cndmask_b32 v28, 0, -1, vcc
L_w44:
    s_cbranch_execz L_w45
    v_cmp_eq_u32 vcc, 7, v3
    s_nop 1
    v_cndmask_b32 v29, 0, -1, vcc
    v_mov_b32 v30, 0xff800000
    v_mov_b32 v31, 0
    v_mov_b32 v36, 0
    v_mov_b32 v37, 0
    v_mov_b32 v38, 0
    v_mov_b32 v39, 0
    s_mov_b32 s4, 0x3fb8aa3b
    s_mov_b32 s5, 0
L_w45:
    s_cbranch_execz L_w46
    s_lshl_b32 s20, s36, 1
    s_add_u32 s20, s20, 2
    v_and_b32 v3, 1, v2
    v_lshlrev_b32 v3, 8, v3
    v_lshl_add_u32 v3, v1, 4, v3
    v_add_u32 v35, 131072, v3
    s_lshl_b32 s37, s36, 9
    s_add_u32 s37, s37, 136192
    v_lshl_add_u32 v77, v0, 3, s37
    s_lshl_b32 s37, s36, 10
L_w46:
    s_cbranch_execz L_w47
    s_add_u32 s37, s37, 132096
    v_lshl_add_u32 v78, v0, 4, s37
    s_lshl_b32 s37, s36, 2
    s_add_u32 s37, s37, 140304
    v_mov_b32 v79, s37
    s_cmp_eq_u32 s36, 0
    s_cselect_b32 s19, 0, 2
L_sp_q:
    s_sleep 1
    ds_read_b32 v6, v81 offset:4
    s_waitcnt lgkmcnt(0)
L_w47:
    s_cbranch_execz L_w48
    v_readfirstlane_b32 s37, v6
    s_nop 0
    s_and_b32 s38, s37, s19
    s_cbranch_scc0 L_sp_q2
    s_mov_b32 s19, 0
    v_bfi_b32 v64, s10, v80, v72
    v_bfi_b32 v65, s10, v148, v73
    v_bfi_b32 v66, s10, v149, v74
    v_bfi_b32 v67, s10, v150, v75
L_w48:
    s_cbranch_execz L_w49
    s_mov_b32 exec_lo, 0x00ff00ff
    s_mov_b32 exec_hi, 0x00ff00ff
    buffer_store_dwordx4 v[64:67], v5, s[48:51], s70 offen sc1
    s_mov_b64 exec, -1
L_sp_q2:
    s_bitcmp1_b32 s37, 0
    s_cbranch_scc0 L_sp_q
    ds_read_b128 v[40:43], v35 offset:0
    ds_read_b128 v[44:47], v35 offset:64
L_w49:
    s_cbranch_execz L_w50
    ds_read_b128 v[48:51], v35 offset:128
    ds_read_b128 v[52:55], v35 offset:192
L_consume:
    ds_read_b32 v6, v81 offset:0
    s_waitcnt lgkmcnt(0)
    v_readfirstlane_b32 s37, v6
    s_nop 0
    s_cmp_lt_u32 s37, s20
    s_cbranch_scc1 L_consume
    s_mov_b32 s19, s37
    ds_read_b128 v[84:87], v10 offset:0
L_w50:
    s_cbranch_execz L_w51
    ds_read_b128 v[88:91], v10 offset:4096
    ds_read_b128 v[92:95], v11 offset:0
    ds_read_b128 v[96:99], v11 offset:4096
    ds_read_b128 v[100:103], v12 offset:0
    ds_read_b128 v[104:107], v12 offset:4096
    ds_read_b128 v[108:111], v13 offset:0
    ds_read_b128 v[112:115], v13 offset:4096
L_w51:
    s_cbranch_execz L_w52
    s_waitcnt lgkmcnt(7)
    v_mfma_f32_16x16x32_bf16 v[56:59], v[84:87], v[40:43], 0
    s_waitcnt lgkmcnt(6)
    v_mfma_f32_16x16x32_bf16 v[60:63], v[88:91], v[40:43], 0
    s_waitcnt lgkmcnt(5)
    v_mfma_f32_16x16x32_bf16 v[56:59], v[92:95], v[44:47], v[56:59]
    s_waitcnt lgkmcnt(4)
    v_mfma_f32_16x16x32_bf16 v[60:63], v[96:99], v[44:47], v[60:63]
    s_waitcnt lgkmcnt(3)
L_w52:
    s_cbranch_execz L_w53
    v_mfma_f32_16x16x32_bf16 v[56:59], v[100:103], v[48:51], v[56:59]
    s_waitcnt lgkmcnt(2)
    v_mfma_f32_16x16x32_bf16 v[60:63], v[104:107], v[48:51], v[60:63]
    s_waitcnt lgkmcnt(1)
    v_mfma_f32_16x16x32_bf16 v[56:59], v[108:111], v[52:55], v[56:59]
    s_waitcnt lgkmcnt(0)
    v_mfma_f32_16x16x32_bf16 v[60:63], v[112:115], v[52:55], v[60:63]
    v_xor_b32 v10, 0x10000, v10
L_w53:
    s_cbranch_execz L_w54
    v_xor_b32 v11, 0x10000, v11
    v_xor_b32 v12, 0x10000, v12
    v_xor_b32 v13, 0x10000, v13
    s_add_u32 s5, s5, 1
    s_add_u32 s20, s20, 8
    s_nop 1
    v_cvt_pk_bf16_f32 v68, v56, v57
    v_cvt_pk_bf16_f32 v69, v58, v59
L_w54:
    s_cbranch_execz L_w55
    v_cvt_pk_bf16_f32 v70, v60, v61
    v_cvt_pk_bf16_f32 v71, v62, v63
    v_lshlrev_b32 v56, 16, v68
    v_and_b32 v57, 0xffff0000, v68
    v_lshlrev_b32 v58, 16, v69
    v_and_b32 v59, 0xffff0000, v69
    v_lshlrev_b32 v60, 16, v70
    v_and_b32 v61, 0xffff0000, v70
    v_lshlrev_b32 v62, 16, v71
L_w55:
    s_cbranch_execz L_w56
    v_and_b32 v63, 0xffff0000, v71
    v_mul_f32 v56, 0x3db504f3, v56
    v_mul_f32 v57, 0x3db504f3, v57
    v_mul_f32 v58, 0x3db504f3, v58
    v_mul_f32 v59, 0x3db504f3, v59
    v_mul_f32 v60, 0x3db504f3, v60
    v_mul_f32 v61, 0x3db504f3, v61
L_w56:
    s_cbranch_execz L_w57
    v_mul_f32 v62, 0x3db504f3, v62
    v_mul_f32 v63, 0x3db504f3, v63
    v_cvt_pk_bf16_f32 v68, v56, v57
    v_cvt_pk_bf16_f32 v69, v58, v59
    v_cvt_pk_bf16_f32 v70, v60, v61
    v_cvt_pk_bf16_f32 v71, v62, v63
    v_lshlrev_b32 v56, 16, v68
L_w57:
    s_cbranch_execz L_w58
    v_and_b32 v57, 0xffff0000, v68
    v_lshlrev_b32 v58, 16, v69
    v_and_b32 v59, 0xffff0000, v69
    v_lshlrev_b32 v60, 16, v70
    v_and_b32 v61, 0xffff0000, v70
    v_lshlrev_b32 v62, 16, v71
    v_and_b32 v63, 0xffff0000, v71
    v_max3_f32 v32, v56, v57, v58
L_w58:
    s_cbranch_execz L_w59
    v_max3_f32 v33, v60, v61, v62
    v_max3_f32 v32, v32, v59, v63
    v_max_f32 v32, v32, v33
    v_mov_b32 v33, v32
    s_nop 1
    v_permlane32_swap_b32 v32, v33
    v_max_f32 v32, v32, v33
    v_mov_b32 v33, v32
    s_nop 1
    v_permlane16_swap_b32 v32, v33
    v_max_f32 v32, v32, v33
    v_mul_f32 v32, s4, v32
L_w59:
    s_cbranch_execz L_w60
    v_max_f32 v32, v32, v30
    v_sub_f32 v34, v30, v32
    v_exp_f32 v34, v34
    v_mov_b32 v30, v32
    v_fma_f32 v56, v56, s4, -v32
    v_fma_f32 v57, v57, s4, -v32
    v_fma_f32 v58, v58, s4, -v32
    v_fma_f32 v59, v59, s4, -v32
    v_fma_f32 v60, v60, s4, -v32
L_w60:
    s_cbranch_execz L_w61
    v_fma_f32 v61, v61, s4, -v32
    v_fma_f32 v62, v62, s4, -v32
    v_fma_f32 v63, v63, s4, -v32
    v_exp_f32 v56, v56
    v_exp_f32 v57, v57
    v_exp_f32 v58, v58
    v_exp_f32 v59, v59
    v_exp_f32 v60, v60
    v_exp_f32 v61, v61
    v_exp_f32 v62, v62
    v_exp_f32 v63, v63
L_w61:
    s_cbranch_execz L_w62
    v_mul_f32 v36, v34, v36
    v_mul_f32 v37, v34, v37
    v_mul_f32 v38, v34, v38
    v_mul_f32 v39, v34, v39
    v_cvt_pk_bf16_f32 v68, v56, v57
    v_cvt_pk_bf16_f32 v69, v58, v59
    v_cvt_pk_bf16_f32 v70, v60, v61
    v_cvt_pk_bf16_f32 v71, v62, v63
    v_add_f32 v56, v56, v57
    v_add_f32 v58, v58, v59
L_w62:
    s_cbranch_execz L_w63
    v_add_f32 v60, v60, v61
    v_add_f32 v62, v62, v63
    v_add_f32 v56, v56, v58
    v_add_f32 v60, v60, v62
    v_add_f32 v56, v56, v60
    v_fma_f32 v31, v31, v34, v56
    v_and_b32 v116, v68, v22
    v_and_b32 v117, v69, v22
    v_and_b32 v118, v70, v22
    v_and_b32 v119, v71, v22
    v_and_b32 v120, v68, v23
    v_and_b32 v121, v69, v23
    v_and_b32 v122, v70, v23
L_w63:
    s_cbranch_execz L_w64
    v_and_b32 v123, v71, v23
    v_and_b32 v124, v68, v24
    v_and_b32 v125, v69, v24
    v_and_b32 v126, v70, v24
    v_and_b32 v127, v71, v24
    v_and_b32 v128, v68, v25
    v_and_b32 v129, v69, v25
    v_and_b32 v130, v70, v25
    v_and_b32 v131, v71, v25
    v_and_b32 v132, v68, v26
    v_and_b32 v133, v69, v26
    v_and_b32 v134, v70, v26
    v_and_b32 v135, v71, v26
    v_and_b32 v136, v68, v27
L_w64:
    s_cbranch_execz L_w65
    v_and_b32 v137, v69, v27
    v_and_b32 v138, v70, v27
    v_and_b32 v139, v71, v27
    v_and_b32 v140, v68, v28
    v_and_b32 v141, v69, v28
    v_and_b32 v142, v70, v28
    v_and_b32 v143, v71, v28
    v_and_b32 v144, v68, v29
    v_and_b32 v145, v69, v29
    v_and_b32 v146, v70, v29
    v_and_b32 v147, v71, v29
    s_cmp_eq_u32 s5, 8
    s_cbranch_scc0 L_notlast
    v_mov_b32 v33, v31
L_w65:
    s_cbranch_execz L_w66
    s_nop 1
    v_permlane32_swap_b32 v31, v33
    v_add_f32 v31, v31, v33
    v_mov_b32 v33, v31
    s_nop 1
    v_permlane16_swap_b32 v31, v33
    v_add_f32 v31, v31, v33
    ds_write_b64 v77, v[30:31]
    v_mov_b32 v33, 1
    s_mov_b64 exec, 1
    ds_add_u32 v81, v33 offset:8
    s_mov_b64 exec, -1
L_w66:
    s_cbranch_execz L_w67
    v_mov_b32 v33, 0x100
L_notlast:
    s_cmp_lt_u32 s19, s20
    s_cbranch_scc0 L_pv
L_sp_v:
    ds_read_b32 v6, v81 offset:0
    s_waitcnt lgkmcnt(0)
    v_readfirstlane_b32 s37, v6
    s_nop 0
    s_cmp_lt_u32 s37, s20
    s_cbranch_scc1 L_sp_v
L_pv:
    ds_read_b64_tr_b16 v[84:85], v14 offset:32768
L_w67:
    s_cbranch_execz L_w68
    ds_read_b64_tr_b16 v[86:87], v14 offset:36864
    ds_read_b64_tr_b16 v[88:89], v15 offset:32768
    ds_read_b64_tr_b16 v[90:91], v15 offset:36864
    ds_read_b64_tr_b16 v[92:93], v16 offset:32768
    ds_read_b64_tr_b16 v[94:95], v16 offset:36864
    ds_read_b64_tr_b16 v[96:97], v17 offset:32768
    ds_read_b64_tr_b16 v[98:99], v17 offset:36864
L_w68:
    s_cbranch_execz L_w69
    ds_read_b64_tr_b16 v[100:101], v18 offset:32768
    ds_read_b64_tr_b16 v[102:103], v18 offset:36864
    ds_read_b64_tr_b16 v[104:105], v19 offset:32768
    ds_read_b64_tr_b16 v[106:107], v19 offset:36864
    ds_read_b64_tr_b16 v[108:109], v20 offset:32768
    ds_read_b64_tr_b16 v[110:111], v20 offset:36864
    ds_read_b64_tr_b16 v[112:113], v21 offset:32768
L_w69:
    s_cbranch_execz L_w70
    ds_read_b64_tr_b16 v[114:115], v21 offset:36864
    s_waitcnt lgkmcnt(14)
    v_mfma_f32_16x16x32_bf16 v[36:39], v[84:87], v[116:119], v[36:39]
    s_waitcnt lgkmcnt(12)
    v_mfma_f32_16x16x32_bf16 v[36:39], v[88:91], v[120:123], v[36:39]
    s_waitcnt lgkmcnt(10)
    v_mfma_f32_16x16x32_bf16 v[36:39], v[92:95], v[124:127], v[36:39]
    s_waitcnt lgkmcnt(8)
    v_mfma_f32_16x16x32_bf16 v[36:39], v[96:99], v[128:131], v[36:39]
L_w70:
    s_cbranch_execz L_w71
    s_waitcnt lgkmcnt(6)
    v_mfma_f32_16x16x32_bf16 v[36:39], v[100:103], v[132:135], v[36:39]
    s_waitcnt lgkmcnt(4)
    v_mfma_f32_16x16x32_bf16 v[36:39], v[104:107], v[136:139], v[36:39]
    s_waitcnt lgkmcnt(2)
    v_mfma_f32_16x16x32_bf16 v[36:39], v[108:111], v[140:143], v[36:39]
    s_waitcnt lgkmcnt(0)
    v_mfma_f32_16x16x32_bf16 v[36:39], v[112:115], v[144:147], v[36:39]
    s_cmp_eq_u32 s5, 8
    s_cbranch_scc1 L_cdone
L_w71:
    s_cbranch_execz L_w72
    v_lshlrev_b32 v32, 0, s5
    ds_write_b32 v79, v32
    v_xor_b32 v14, 0x10000, v14
    v_xor_b32 v15, 0x10000, v15
    v_xor_b32 v16, 0x10000, v16
    v_xor_b32 v17, 0x10000, v17
    v_xor_b32 v18, 0x10000, v18
L_w72:
    s_cbranch_execz L_w73
    v_xor_b32 v19, 0x10000, v19
    v_xor_b32 v20, 0x10000, v20
    v_xor_b32 v21, 0x10000, v21
    s_add_u32 s20, s20, 8
    s_branch L_consume
L_cdone:
    s_nop 5
    ds_write_b128 v78, v[36:39]
    s_mov_b64 exec, 1
    ds_add_u32 v81, v33 offset:8
L_w73:
    s_cbranch_execz L_w74
    s_mov_b64 exec, -1
L_outproj:
    v_lshrrev_b32 v3, 2, v2
    v_lshl_add_u32 v3, v1, 2, v3
    v_mul_u32_u24 v3, 288, v3
    v_and_b32 v4, 3, v2
    v_lshl_add_u32 v3, v4, 3, v3
    s_cmp_gt_u32 s36, 5
    s_subb_u32 s5, s36, 0
    s_lshl_b32 s37, s5, 5
    v_add_u32 v3, s37, v3
    v_and_b32 v5, 1, v2
L_w74:
    s_cbranch_execz L_w75
    v_lshlrev_b32 v7, 8, v5
    v_lshl_add_u32 v7, v1, 3, v7
    v_add_u32 v7, 131584, v7
    v_lshlrev_b32 v5, 6, v5
    v_lshl_add_u32 v5, v1, 4, v5
    s_lshl_b32 s37, s32, 2
    s_add_u32 s37, s37, s35
    s_lshl_b32 s37, s37, 5
    s_lshl_b32 s38, s33, 1
    s_add_u32 s38, s38, s34
    s_add_u32 s37, s37, s38
L_w75:
    s_cbranch_execz L_w76
    s_mul_i32 s8, s37, 1152
    s_add_u32 s8, s8, 1572864
    s_lshl_b32 s37, s5, 7
    s_add_u32 s8, s8, s37
L_sp_wo:
    ds_read_b32 v6, v81 offset:8
    s_waitcnt lgkmcnt(0)
    v_readfirstlane_b32 s37, v6
    s_nop 0
    s_bfe_u32 s37, s37, 0x80010
    s_cmp_lt_u32 s37, 3
L_w76:
    s_cbranch_execz L_w77
    s_cbranch_scc1 L_sp_wo
    ds_read_b64_tr_b16 v[24:25], v3 offset:0
    ds_read_b64_tr_b16 v[26:27], v3 offset:4608
    ds_read_b64_tr_b16 v[28:29], v3 offset:9216
    ds_read_b64_tr_b16 v[30:31], v3 offset:13824
    ds_read_b64_tr_b16 v[32:33], v3 offset:18432
    ds_read_b64_tr_b16 v[34:35], v3 offset:23040
L_w77:
    s_cbranch_execz L_w78
    ds_read_b64_tr_b16 v[36:37], v3 offset:27648
    ds_read_b64_tr_b16 v[38:39], v3 offset:32256
    s_waitcnt lgkmcnt(0)
    s_barrier
    ds_read2_b64 v[8:11], v7 offset0:0 offset1:4
    ds_read2_b64 v[12:15], v7 offset0:8 offset1:12
    ds_read2_b64 v[16:19], v7 offset0:16 offset1:20
    ds_read2_b64 v[20:23], v7 offset0:24 offset1:28
L_w78:
    s_cbranch_execz L_w79
    s_waitcnt lgkmcnt(3)
    v_mfma_f32_16x16x32_bf16 v[40:43], v[24:27], v[8:11], 0
    s_waitcnt lgkmcnt(2)
    v_mfma_f32_16x16x32_bf16 v[40:43], v[28:31], v[12:15], v[40:43]
    s_waitcnt lgkmcnt(1)
    v_mfma_f32_16x16x32_bf16 v[40:43], v[32:35], v[16:19], v[40:43]
    s_waitcnt lgkmcnt(0)
    v_mfma_f32_16x16x32_bf16 v[40:43], v[36:39], v[20:23], v[40:43]
    s_mov_b32 exec_lo, 0x00030003
L_w79:
    s_cbranch_execz L_w80
    s_mov_b32 exec_hi, 0x00030003
    s_nop 5
    v_bfi_b32 v40, s10, v80, v40
    v_bfi_b32 v41, s10, v148, v41
    v_bfi_b32 v42, s10, v149, v42
    v_bfi_b32 v43, s10, v150, v43
    buffer_store_dwordx4 v[40:43], v5, s[48:51], s8 offen sc1
    s_cmp_eq_u32 s36, 0
L_w80:
    s_cbranch_execz L_w81
    s_cbranch_scc0 L_fin
    v_mov_b32 v4, 0x2000000
    s_mov_b64 exec, 1
    s_nop 0
    ds_add_u32 v81, v4 offset:8
L_fin:
L_end:
    s_endpgm
L_fb:
    v_mov_b32 v7, 2
    ds_write_b32 v81, v7 offset:4
    v_mov_b32 v7, 3
    s_mov_b32 s68, 2097152
    s_xor_b32 s69, s71, s3
    s_waitcnt vmcnt(0)
    v_bfi_b32 v64, s10, v80, v72
    v_bfi_b32 v65, s10, v148, v73
    v_bfi_b32 v66, s10, v149, v74
    v_bfi_b32 v67, s10, v150, v75
    s_mov_b32 exec_lo, 0x00ff00ff
    s_mov_b32 exec_hi, 0x00ff00ff
    buffer_store_dwordx4 v[64:67], v5, s[48:51], s70 offen sc1
    s_mov_b64 exec, -1
    s_branch L_pq_k
L_hi:
    s_cmp_eq_u32 s36, 4
    s_cbranch_scc0 L_567
    s_setprio 1
    v_lshrrev_b32 v1, 4, v0
    v_and_b32 v2, 15, v0
    v_xor_b32 v3, v2, v1
    v_lshlrev_b32 v3, 4, v3
    v_lshl_add_u32 v4, v1, 8, v3
    v_xor_b32 v5, 64, v4
    v_xor_b32 v6, 0x80, v4
    v_xor_b32 v7, 0xc0, v4
    v_lshlrev_b32 v3, 1, v1
    v_xor_b32 v3, v2, v3
    v_lshlrev_b32 v3, 4, v3
    v_lshl_add_u32 v8, v1, 8, v3
    v_xor_b32 v9, 0x80, v8
    s_lshl_b32 s37, s34, 4
    s_add_u32 s37, s37, s33
    s_lshl_b32 s37, s37, 2
    s_add_u32 s37, s37, s35
    s_lshl_b32 s37, s37, 18
    s_mov_b32 s42, 262144
    s_mov_b32 s43, 0x20000
    s_mov_b32 s46, 262144
    s_mov_b32 s47, 0x20000
    s_cmp_eq_u32 s32, 0
    s_waitcnt lgkmcnt(0)
    s_cselect_b64 s[40:41], s[6:7], s[16:17]
    s_cselect_b64 s[44:45], s[8:9], s[18:19]
    s_add_u32 s40, s40, s37
    s_addc_u32 s41, s41, 0
    s_add_u32 s44, s44, s37
    s_addc_u32 s45, s45, 0
    s_lshl_b32 s38, s32, 8
    s_load_dword s39, s[28:29], s38
    s_mul_i32 s7, s35, 32768
    s_mov_b32 s8, 0
    s_mov_b32 s5, 0
    v_mov_b32 v81, 140288
    v_mov_b32 v10, -12
    v_mov_b32 v11, 0
    v_mov_b32 v16, 0
    s_lshl_b32 s72, s31, 12
    s_waitcnt lgkmcnt(0)
    s_barrier
L_load:
    s_sub_u32 s37, s5, 1
    s_cmp_lt_u32 s37, 6
    s_cselect_b64 vcc, -1, 0
    s_cselect_b32 s83, 5, 0
    s_mov_b32 s73, s8
    s_add_u32 s74, s73, 32768
L_tile0:
    s_mov_b32 m0, s73
    s_add_u32 s38, s7, s72
    s_add_u32 s72, s72, 4096
    s_and_b32 s72, s72, 0x7fff
    s_add_u32 s73, s73, 4096
    s_waitcnt lgkmcnt(0)
    v_readfirstlane_b32 s84, v16
    ds_read_b32 v16, v81 offset:12
    s_cbranch_vccz L_nl0
    s_waitcnt vmcnt(26)
    s_cmp_eq_u32 s84, 1
    s_cbranch_scc1 L_nl0
    s_waitcnt vmcnt(19)
L_nl0:
    s_waitcnt vmcnt(48)
    v_add_u32 v12, s83, v10
    v_max_i32 v11, v11, v12
    ds_write_b32 v81, v11
    v_add_u32 v10, 1, v10
    buffer_load_dwordx4 v4, s[40:43], s38 offen offset:0 nt lds
    s_cbranch_vccz L_nl1
    s_waitcnt vmcnt(26)
L_nl1:
    s_waitcnt vmcnt(48)
    buffer_load_dwordx4 v5, s[40:43], s38 offen offset:1024 nt lds
    s_cbranch_vccz L_nl2
    s_waitcnt vmcnt(26)
    s_cmp_eq_u32 s84, 1
    s_cbranch_scc1 L_nl2
    s_waitcnt vmcnt(19)
L_nl2:
    s_waitcnt vmcnt(48)
    buffer_load_dwordx4 v6, s[40:43], s38 offen offset:2048 nt lds
    s_cbranch_vccz L_nl3
    s_waitcnt vmcnt(26)
L_nl3:
    s_waitcnt vmcnt(48)
    buffer_load_dwordx4 v7, s[40:43], s38 offen offset:3072 nt lds
    s_cmp_lt_u32 s73, s74
    s_cbranch_scc1 L_tile0
    s_add_u32 s74, s73, 32768
L_tile1:
    s_mov_b32 m0, s73
    s_add_u32 s38, s7, s72
    s_add_u32 s72, s72, 4096
    s_and_b32 s72, s72, 0x7fff
    s_add_u32 s73, s73, 4096
    s_waitcnt lgkmcnt(0)
    v_readfirstlane_b32 s84, v16
    ds_read_b32 v16, v81 offset:12
    s_cbranch_vccz L_nl4
    s_waitcnt vmcnt(26)
    s_cmp_eq_u32 s84, 1
    s_cbranch_scc1 L_nl4
    s_waitcnt vmcnt(19)
L_nl4:
    s_waitcnt vmcnt(48)
    v_add_u32 v12, s83, v10
    v_max_i32 v11, v11, v12
    ds_write_b32 v81, v11
    v_add_u32 v10, 1, v10
    buffer_load_dwordx4 v8, s[44:47], s38 offen offset:0 nt lds
    s_cbranch_vccz L_nl5
    s_waitcnt vmcnt(26)
L_nl5:
    s_waitcnt vmcnt(48)
    buffer_load_dwordx4 v9, s[44:47], s38 offen offset:1024 nt lds
    s_cbranch_vccz L_nl6
    s_waitcnt vmcnt(26)
    s_cmp_eq_u32 s84, 1
    s_cbranch_scc1 L_nl6
    s_waitcnt vmcnt(19)
L_nl6:
    s_waitcnt vmcnt(48)
    buffer_load_dwordx4 v8, s[44:47], s38 offen offset:2048 nt lds
    s_cbranch_vccz L_nl7
    s_waitcnt vmcnt(26)
L_nl7:
    s_waitcnt vmcnt(48)
    buffer_load_dwordx4 v9, s[44:47], s38 offen offset:3072 nt lds
    s_cmp_lt_u32 s73, s74
    s_cbranch_scc1 L_tile1
    s_add_u32 s7, s7, 32768
    s_and_b32 s7, s7, 262143
    s_xor_b32 s8, s8, 0x10000
    s_add_u32 s5, s5, 1
    s_cmp_lt_u32 s5, 2
    s_cbranch_scc1 L_load
    s_cmp_eq_u32 s5, 8
    s_cbranch_scc1 L_ldone
    s_sub_u32 s20, s5, 1
L_free:
    ds_read_b128 v[12:15], v81 offset:16
    s_waitcnt lgkmcnt(0)
    v_min_u32 v12, v12, v13
    v_min3_u32 v12, v12, v14, v15
    s_nop 0
    v_readfirstlane_b32 s37, v12
    s_nop 0
    s_cmp_lt_u32 s37, s20
    s_cbranch_scc1 L_free
    s_branch L_load
L_ldone:
    v_mov_b32 v11, 116
    s_waitcnt vmcnt(48)
    ds_write_b32 v81, v11
    v_mov_b32 v11, 117
    s_waitcnt vmcnt(44)
    ds_write_b32 v81, v11
    v_mov_b32 v11, 118
    s_waitcnt vmcnt(40)
    ds_write_b32 v81, v11
    v_mov_b32 v11, 119
    s_waitcnt vmcnt(36)
    ds_write_b32 v81, v11
    v_mov_b32 v11, 120
    s_waitcnt vmcnt(32)
    ds_write_b32 v81, v11
    v_mov_b32 v11, 121
    s_waitcnt vmcnt(28)
    ds_write_b32 v81, v11
    v_mov_b32 v11, 122
    s_waitcnt vmcnt(24)
    ds_write_b32 v81, v11
    v_mov_b32 v11, 123
    s_waitcnt vmcnt(20)
    ds_write_b32 v81, v11
    v_mov_b32 v11, 124
    s_waitcnt vmcnt(16)
    ds_write_b32 v81, v11
    v_mov_b32 v11, 125
    s_waitcnt vmcnt(12)
    ds_write_b32 v81, v11
    v_mov_b32 v11, 126
    s_waitcnt vmcnt(8)
    ds_write_b32 v81, v11
    v_mov_b32 v11, 127
    s_waitcnt vmcnt(4)
    ds_write_b32 v81, v11
    v_mov_b32 v11, 128
    s_waitcnt vmcnt(0)
    ds_write_b32 v81, v11
    s_setprio 0
    s_mov_b32 s48, s28
    s_mov_b32 s49, s29
    s_mov_b32 s50, 4194304
    s_mov_b32 s51, 0x20000
    v_lshrrev_b32 v1, 4, v0
    v_and_b32 v2, 15, v0
    v_mov_b32 v81, 140288
    s_mov_b32 s10, 0xff
    s_add_u32 s39, s39, 1
    s_and_b32 s3, s39, 0xff
    s_bfe_u32 s77, s39, 0x80008
    s_bfe_u32 s78, s39, 0x80010
    s_lshr_b32 s79, s39, 24
    v_mov_b32 v80, s3
    v_mov_b32 v148, s77
    v_mov_b32 v149, s78
    v_mov_b32 v150, s79
    s_getreg_b32 s21, hwreg(HW_REG_XCC_ID)
    s_and_b32 s21, s21, 7
    s_lshl_b32 s21, s21, 5
    s_add_u32 s21, s21, s39
    s_lshl_b32 s85, s21, 8
    s_and_b32 s21, s21, 0xff
    s_branch L_outproj
L_567:
    v_mov_b32 v4, 0
    v_lshlrev_b32 v3, 2, v0
    v_add_u32 v3, 140288, v3
    s_mov_b64 exec, 0xffff
    ds_write_b32 v3, v4
    s_mov_b64 exec, -1
    s_waitcnt lgkmcnt(0)
    s_lshl_b32 s38, s32, 8
    s_load_dword s39, s[28:29], s38
    s_mov_b32 s48, s28
    s_mov_b32 s49, s29
    s_mov_b32 s50, 4194304
    s_mov_b32 s51, 0x20000
    v_lshrrev_b32 v1, 4, v0
    v_and_b32 v2, 15, v0
    v_mov_b32 v81, 140288
    s_mov_b32 s10, 0xff
    s_waitcnt lgkmcnt(0)
    s_barrier
    s_add_u32 s39, s39, 1
    s_and_b32 s3, s39, 0xff
    s_bfe_u32 s77, s39, 0x80008
    s_bfe_u32 s78, s39, 0x80010
    s_lshr_b32 s79, s39, 24
    v_mov_b32 v80, s3
    v_mov_b32 v148, s77
    v_mov_b32 v149, s78
    v_mov_b32 v150, s79
    s_getreg_b32 s21, hwreg(HW_REG_XCC_ID)
    s_and_b32 s21, s21, 7
    s_lshl_b32 s21, s21, 5
    s_add_u32 s21, s21, s39
    s_lshl_b32 s85, s21, 8
    s_and_b32 s21, s21, 0xff
    s_cmp_eq_u32 s36, 7
    s_cbranch_scc0 L_warmed
    s_mov_b64 exec, 0
    s_branch L_w0
L_warmed:
    s_cmp_eq_u32 s36, 6
    s_cbranch_scc1 L_comb
    s_cmp_eq_u32 s36, 5
    s_cbranch_scc1 L_hop1
    s_mul_i32 s37, s32, 40
    s_add_u32 s37, s37, 32
    s_load_dwordx2 s[60:61], s[0:1], s37
    s_sub_u32 s19, s36, 7
    s_mul_i32 s19, s19, 768
    v_add_u32 v5, s19, v0
    s_mul_i32 s19, s19, 16
    s_mov_b32 s37, 3641
    s_movk_i32 s38, 864
    v_add_u32 v3, 0, v5
    v_mul_lo_u32 v4, v3, s37
    v_lshrrev_b32 v4, 16, v4
    v_mul_lo_u32 v4, v4, s38
    v_lshl_add_u32 v84, v3, 4, v4
    v_add_u32 v3, 64, v5
    v_mul_lo_u32 v4, v3, s37
    v_lshrrev_b32 v4, 16, v4
    v_mul_lo_u32 v4, v4, s38
    v_lshl_add_u32 v85, v3, 4, v4
    v_add_u32 v3, 128, v5
    v_mul_lo_u32 v4, v3, s37
    v_lshrrev_b32 v4, 16, v4
    v_mul_lo_u32 v4, v4, s38
    v_lshl_add_u32 v86, v3, 4, v4
    v_add_u32 v3, 192, v5
    v_mul_lo_u32 v4, v3, s37
    v_lshrrev_b32 v4, 16, v4
    v_mul_lo_u32 v4, v4, s38
    v_lshl_add_u32 v87, v3, 4, v4
    v_add_u32 v3, 256, v5
    v_mul_lo_u32 v4, v3, s37
    v_lshrrev_b32 v4, 16, v4
    v_mul_lo_u32 v4, v4, s38
    v_lshl_add_u32 v88, v3, 4, v4
    v_add_u32 v3, 320, v5
    v_mul_lo_u32 v4, v3, s37
    v_lshrrev_b32 v4, 16, v4
    v_mul_lo_u32 v4, v4, s38
    v_lshl_add_u32 v89, v3, 4, v4
    v_add_u32 v3, 384, v5
    v_mul_lo_u32 v4, v3, s37
    v_lshrrev_b32 v4, 16, v4
    v_mul_lo_u32 v4, v4, s38
    v_lshl_add_u32 v90, v3, 4, v4
    v_add_u32 v3, 448, v5
    v_mul_lo_u32 v4, v3, s37
    v_lshrrev_b32 v4, 16, v4
    v_mul_lo_u32 v4, v4, s38
    v_lshl_add_u32 v91, v3, 4, v4
    v_add_u32 v3, 512, v5
    v_mul_lo_u32 v4, v3, s37
    v_lshrrev_b32 v4, 16, v4
    v_mul_lo_u32 v4, v4, s38
    v_lshl_add_u32 v92, v3, 4, v4
    v_add_u32 v3, 576, v5
    v_mul_lo_u32 v4, v3, s37
    v_lshrrev_b32 v4, 16, v4
    v_mul_lo_u32 v4, v4, s38
    v_lshl_add_u32 v93, v3, 4, v4
    v_add_u32 v3, 640, v5
    v_mul_lo_u32 v4, v3, s37
    v_lshrrev_b32 v4, 16, v4
    v_mul_lo_u32 v4, v4, s38
    v_lshl_add_u32 v94, v3, 4, v4
    v_add_u32 v3, 704, v5
    v_mul_lo_u32 v4, v3, s37
    v_lshrrev_b32 v4, 16, v4
    v_mul_lo_u32 v4, v4, s38
    v_lshl_add_u32 v95, v3, 4, v4
    s_lshl_b32 s37, s33, 1
    s_add_u32 s37, s37, s34
    s_mul_i32 s37, s37, 147456
    s_mul_i32 s38, s35, 288
    s_add_u32 s37, s37, s38
    s_waitcnt lgkmcnt(0)
    s_add_u32 s60, s60, s37
    s_addc_u32 s61, s61, 0
    s_mov_b32 s62, 146592
    s_mov_b32 s63, 0x20000
    s_cmp_eq_u32 s36, 8
    s_cbranch_scc0 L_57
    s_lshl_b32 s16, s30, 7
    s_add_u32 s16, s16, 32768
    s_lshl_b32 s7, s31, 2
    s_add_u32 s7, s7, s16
    s_mov_b32 s4, s85
    v_lshlrev_b32 v8, 2, v0
    v_mov_b32 v9, 0
L_sp_ct:
    s_sleep 8
    ds_read_b32 v6, v81 offset:0
    s_waitcnt lgkmcnt(0)
    v_readfirstlane_b32 s37, v6
    s_nop 0
    s_cmp_lt_u32 s37, 20
    s_cbranch_scc1 L_sp_ct
L_ctl:
    ds_read_b32 v6, v81
    s_waitcnt lgkmcnt(0)
    v_readfirstlane_b32 s5, v6
    v_or_b32 v7, s4, v6
    s_mov_b64 exec, 1
    buffer_store_dword v7, v9, s[48:51], s7 offen
    s_mov_b64 exec, 0xff
    s_sleep 8
    buffer_load_dword v10, v8, s[48:51], s16 offen sc1
    s_waitcnt vmcnt(0)
    v_subrev_u32 v10, s4, v10
    v_cmp_lt_u32 vcc, 0xff, v10
    s_cbranch_vccnz L_ctl_n
    v_readlane_b32 s72, v10, s31
    v_readlane_b32 s73, v10, 0
    v_readlane_b32 s74, v10, 1
    v_readlane_b32 s75, v10, 2
    v_readlane_b32 s76, v10, 3
    v_readlane_b32 s80, v10, 4
    v_readlane_b32 s81, v10, 5
    v_readlane_b32 s82, v10, 6
    v_readlane_b32 s83, v10, 7
    s_add_u32 s73, s73, s74
    s_add_u32 s75, s75, s76
    s_add_u32 s80, s80, s81
    s_add_u32 s82, s82, s83
    s_add_u32 s73, s73, s75
    s_add_u32 s80, s80, s82
    s_add_u32 s73, s73, s80
    s_lshl_b32 s72, s72, 3
    s_add_u32 s72, s72, 0
    s_cmp_lt_u32 s72, s73
    s_cselect_b32 s73, 1, 0
    v_mov_b32 v11, s73
    ds_write_b32 v81, v11 offset:12
L_ctl_n:
    s_mov_b64 exec, -1
    s_cmp_lt_u32 s5, 104
    s_cbranch_scc1 L_ctl
L_57:
L_sp_a7:
    s_sleep 8
    ds_read_b32 v6, v81 offset:0
    s_waitcnt lgkmcnt(0)
    v_readfirstlane_b32 s37, v6
    s_nop 0
    s_cmp_lt_u32 s37, 108
    s_cbranch_scc1 L_sp_a7
L_sp_b7:
    ds_read_b32 v6, v81 offset:0
    s_waitcnt lgkmcnt(0)
    v_readfirstlane_b32 s37, v6
    s_nop 0
    s_cmp_lt_u32 s37, 116
    s_cbranch_scc1 L_sp_b7
L_sp_c7:
    ds_read_b128 v[100:103], v81 offset:16
    s_waitcnt lgkmcnt(0)
    v_min_u32 v100, v100, v101
    v_min3_u32 v100, v100, v102, v103
    s_nop 0
    v_readfirstlane_b32 s37, v100
    s_nop 0
    s_cmp_lt_u32 s37, 7
    s_cbranch_scc1 L_sp_c7
    s_add_u32 m0, s19, 0
    s_nop 0
    buffer_load_dwordx4 v84, s[60:63], 0 offen nt lds
    s_add_u32 m0, s19, 1024
    s_nop 0
    buffer_load_dwordx4 v85, s[60:63], 0 offen nt lds
    s_add_u32 m0, s19, 2048
    s_nop 0
    buffer_load_dwordx4 v86, s[60:63], 0 offen nt lds
    s_add_u32 m0, s19, 3072
    s_nop 0
    buffer_load_dwordx4 v87, s[60:63], 0 offen nt lds
    s_add_u32 m0, s19, 4096
    s_nop 0
    buffer_load_dwordx4 v88, s[60:63], 0 offen nt lds
    s_add_u32 m0, s19, 5120
    s_nop 0
    buffer_load_dwordx4 v89, s[60:63], 0 offen nt lds
    s_add_u32 m0, s19, 6144
    s_nop 0
    buffer_load_dwordx4 v90, s[60:63], 0 offen nt lds
    s_add_u32 m0, s19, 7168
    s_nop 0
    buffer_load_dwordx4 v91, s[60:63], 0 offen nt lds
    s_add_u32 m0, s19, 8192
    s_nop 0
    buffer_load_dwordx4 v92, s[60:63], 0 offen nt lds
    s_add_u32 m0, s19, 9216
    s_nop 0
    buffer_load_dwordx4 v93, s[60:63], 0 offen nt lds
    s_add_u32 m0, s19, 10240
    s_nop 0
    buffer_load_dwordx4 v94, s[60:63], 0 offen nt lds
    s_add_u32 m0, s19, 11264
    s_nop 0
    buffer_load_dwordx4 v95, s[60:63], 0 offen nt lds
    v_mov_b32 v4, 0x10000
    s_waitcnt vmcnt(0)
    s_mov_b64 exec, 1
    ds_add_u32 v81, v4 offset:8
    s_mov_b64 exec, -1
    s_branch L_outproj
L_comb:
    v_lshlrev_b32 v8, 4, v0
    v_add_u32 v8, 132096, v8
    v_lshlrev_b32 v9, 3, v0
    v_add_u32 v9, 136192, v9
    v_and_b32 v10, 1, v2
    v_lshlrev_b32 v10, 9, v10
    v_lshrrev_b32 v11, 1, v2
    v_lshl_add_u32 v10, v11, 6, v10
    v_lshl_add_u32 v10, v1, 4, v10
    v_lshlrev_b32 v11, 4, v0
    v_add_u32 v11, 1024, v11
    s_lshl_b32 s37, s30, 3
    s_add_u32 s37, s37, s31
    s_mul_i32 s8, s37, 1152
    s_add_u32 s8, s8, 1048576
    s_add_u32 s7, s8, 2097152
    v_mov_b32 v82, s21
L_sp_m6:
    s_sleep 8
    ds_read_b32 v6, v81 offset:4
    s_waitcnt lgkmcnt(0)
    v_readfirstlane_b32 s37, v6
    s_nop 0
    s_cmp_lt_u32 s37, 1
    s_cbranch_scc1 L_sp_m6
    s_and_b32 s17, s37, 2
L_sp_a6:
    s_sleep 8
    ds_read_b32 v6, v81 offset:0
    s_waitcnt lgkmcnt(0)
    v_readfirstlane_b32 s37, v6
    s_nop 0
    s_cmp_lt_u32 s37, 108
    s_cbranch_scc1 L_sp_a6
L_sp_ml:
L_w81:
    s_cbranch_execz L_w82
    ds_read_b32 v6, v81 offset:8
    s_waitcnt lgkmcnt(0)
    v_readfirstlane_b32 s37, v6
    s_nop 0
    s_bfe_u32 s37, s37, 0x80000
    s_cmp_lt_u32 s37, 4
    s_cbranch_scc1 L_sp_ml
    ds_read_b64 v[32:33], v9 offset:0
    ds_read_b64 v[34:35], v9 offset:512
L_w82:
    s_cbranch_execz L_w83
    ds_read_b64 v[36:37], v9 offset:1024
    ds_read_b64 v[38:39], v9 offset:1536
    s_waitcnt lgkmcnt(0)
    v_max3_f32 v40, v32, v34, v36
    v_max_f32 v40, v40, v38
    v_sub_f32 v32, v32, v40
    v_sub_f32 v34, v34, v40
    v_sub_f32 v36, v36, v40
    v_sub_f32 v38, v38, v40
    v_exp_f32 v32, v32
    v_exp_f32 v34, v34
L_w83:
    s_cbranch_execz L_w84
    v_exp_f32 v36, v36
    v_exp_f32 v38, v38
    s_nop 0
    v_mul_f32 v41, v32, v33
    v_fmac_f32 v41, v34, v35
    v_fmac_f32 v41, v36, v37
    v_fmac_f32 v41, v38, v39
    v_rcp_f32 v42, v41
    v_log_f32 v43, v41
    s_nop 0
    v_add_f32 v43, v43, v40
    v_bfi_b32 v48, s10, v82, v43
L_w84:
    s_cbranch_execz L_w85
    v_bfi_b32 v52, s10, v80, v43
    v_bfi_b32 v49, s10, v148, v43
    v_bfi_b32 v50, s10, v149, v43
    v_bfi_b32 v51, s10, v150, v43
    s_mov_b64 exec, 3
    buffer_store_dwordx4 v[48:51], v11, s[48:51], s7 offen
    s_cmp_eq_u32 s17, 0
    s_cbranch_scc1 L_pub1
    v_mov_b32 v53, v49
L_w85:
    s_cbranch_execz L_w86
    v_mov_b32 v54, v50
    v_mov_b32 v55, v51
    buffer_store_dwordx4 v[52:55], v11, s[48:51], s8 offen sc1
L_pub1:
    s_mov_b64 exec, -1
    v_mul_f32 v32, v32, v42
    v_mul_f32 v34, v34, v42
    v_mul_f32 v36, v36, v42
    v_mul_f32 v38, v38, v42
L_sp_acc:
    ds_read_b32 v6, v81 offset:8
    s_waitcnt lgkmcnt(0)
    v_readfirstlane_b32 s37, v6
    s_nop 0
L_w86:
    s_cbranch_execz L_w87
    s_bfe_u32 s37, s37, 0x80008
    s_cmp_lt_u32 s37, 4
    s_cbranch_scc1 L_sp_acc
    ds_read_b128 v[16:19], v8 offset:0
    ds_read_b128 v[20:23], v8 offset:1024
    ds_read_b128 v[24:27], v8 offset:2048
    ds_read_b128 v[28:31], v8 offset:3072
    s_waitcnt lgkmcnt(3)
L_w87:
    s_cbranch_execz L_w88
    v_pk_mul_f32 v[44:45], v[16:17], v[32:33] op_sel_hi:[1,0]
    v_pk_mul_f32 v[46:47], v[18:19], v[32:33] op_sel_hi:[1,0]
    s_waitcnt lgkmcnt(2)
    v_pk_fma_f32 v[44:45], v[20:21], v[34:35], v[44:45] op_sel_hi:[1,0,1]
    v_pk_fma_f32 v[46:47], v[22:23], v[34:35], v[46:47] op_sel_hi:[1,0,1]
    s_waitcnt lgkmcnt(1)
    v_pk_fma_f32 v[44:45], v[24:25], v[36:37], v[44:45] op_sel_hi:[1,0,1]
    v_pk_fma_f32 v[46:47], v[26:27], v[36:37], v[46:47] op_sel_hi:[1,0,1]
L_w88:
    s_cbranch_execz L_w89
    s_waitcnt lgkmcnt(0)
    v_pk_fma_f32 v[44:45], v[28:29], v[38:39], v[44:45] op_sel_hi:[1,0,1]
    v_pk_fma_f32 v[46:47], v[30:31], v[38:39], v[46:47] op_sel_hi:[1,0,1]
    v_bfi_b32 v56, s10, v82, v44
    v_bfi_b32 v57, s10, v148, v45
    v_bfi_b32 v58, s10, v149, v46
    v_bfi_b32 v59, s10, v150, v47
L_w89:
    s_cbranch_execz L_w90
    buffer_store_dwordx4 v[56:59], v10, s[48:51], s7 offen
    s_cmp_eq_u32 s17, 0
    s_cbranch_scc1 L_pub2
    v_bfi_b32 v44, s10, v80, v44
    v_bfi_b32 v45, s10, v148, v45
    v_bfi_b32 v46, s10, v149, v46
    v_bfi_b32 v47, s10, v150, v47
    buffer_store_dwordx4 v[44:47], v10, s[48:51], s8 offen sc1
L_pub2:
L_w90:
    s_cbranch_execz L_w91
    v_mov_b32 v4, 0x1000000
    s_mov_b64 exec, 1
    ds_add_u32 v81, v4 offset:8
    s_mov_b64 exec, -1
    s_branch L_outproj
L_hop1:
    v_lshrrev_b32 v12, 5, v0
    v_mul_u32_u24 v12, 4608, v12
    v_and_b32 v6, 31, v0
    v_lshl_add_u32 v8, v6, 4, v12
    s_lshl_b32 s37, s34, 9
    v_add_u32 v8, s37, v8
    s_lshl_b32 s37, s34, 4
    s_add_u32 s37, s37, 1024
    v_add_u32 v12, s37, v12
    v_lshlrev_b32 v56, 3, v0
    v_add_u32 v56, 131584, v56
    s_mul_i32 s16, s30, 9216
    s_add_u32 s16, s16, 3145728
    v_lshrrev_b32 v57, 3, v0
    v_mul_u32_u24 v57, 4608, v57
    v_and_b32 v58, 7, v0
    v_lshl_add_u32 v57, v58, 4, v57
    v_lshrrev_b32 v5, 2, v58
    v_mul_u32_u24 v5, 1152, v5
    v_and_b32 v58, 3, v58
    v_lshl_add_u32 v58, v58, 2, v1
    s_mul_i32 s37, s32, 576
    s_mul_i32 s38, s35, 144
    s_add_u32 s37, s37, s38
    s_lshl_b32 s38, s33, 4
    s_add_u32 s37, s37, s38
    v_add3_u32 v58, v58, v5, s37
    v_lshlrev_b32 v58, 1, v58
    s_mov_b32 s64, s24
    s_mov_b32 s65, s25
    s_mov_b32 s66, 4608
    s_mov_b32 s67, 0x20000
    s_lshl_b32 s37, s32, 2
    s_add_u32 s37, s37, s35
    s_mul_i32 s72, s37, 36864
    s_lshl_b32 s37, s33, 7
    s_add_u32 s72, s72, s37
    s_add_u32 s72, s72, 1572864
    s_lshl_b32 s37, s34, 4
    s_add_u32 s73, s37, s33
L_sp_m5:
    s_sleep 8
    ds_read_b32 v6, v81 offset:4
    s_waitcnt lgkmcnt(0)
    v_readfirstlane_b32 s37, v6
    s_nop 0
    s_cmp_lt_u32 s37, 1
    s_cbranch_scc1 L_sp_m5
    s_mov_b32 s71, s21
    s_xor_b32 s69, s71, s3
    s_bitcmp1_b32 s37, 1
    s_cselect_b32 s68, 2097152, 0
    s_cselect_b32 s69, s69, 0
L_sp_a5:
    s_sleep 8
    ds_read_b32 v6, v81 offset:0
    s_waitcnt lgkmcnt(0)
    v_readfirstlane_b32 s37, v6
    s_nop 0
    s_cmp_lt_u32 s37, 108
    s_cbranch_scc1 L_sp_a5
L_sp_b5:
L_w91:
    s_cbranch_execz L_w92
    s_sleep 12
    ds_read_b32 v6, v81 offset:8
    s_waitcnt lgkmcnt(0)
    v_readfirstlane_b32 s37, v6
    s_nop 0
    s_bfe_u32 s37, s37, 0x80018
    s_cmp_lt_u32 s37, 1
    s_cbranch_scc1 L_sp_b5
    s_mov_b32 s9, 2097151
L_pl:
    buffer_load_dwordx4 v[32:35], v12, s[48:51], s16 offen sc1
L_w92:
    s_cbranch_execz L_w93
    buffer_load_dwordx4 v[36:39], v12, s[48:51], s16 offen offset:1152 sc1
    buffer_load_dwordx4 v[40:43], v12, s[48:51], s16 offen offset:2304 sc1
    buffer_load_dwordx4 v[44:47], v12, s[48:51], s16 offen offset:3456 sc1
    buffer_load_dwordx4 v[16:19], v8, s[48:51], s16 offen sc1
    buffer_load_dwordx4 v[20:23], v8, s[48:51], s16 offen offset:1152 sc1
    buffer_load_dwordx4 v[24:27], v8, s[48:51], s16 offen offset:2304 sc1
    buffer_load_dwordx4 v[28:31], v8, s[48:51], s16 offen offset:3456 sc1
L_w93:
    s_cbranch_execz L_w94
    s_sub_u32 s9, s9, 1
    s_cbranch_scc1 L_pl_d
    s_waitcnt vmcnt(7)
    v_xor_b32 v32, s71, v32
    v_xor_b32 v33, s77, v33
    v_xor_b32 v34, s78, v34
    v_xor_b32 v35, s79, v35
    v_or3_b32 v6, v32, v33, v34
    v_or_b32 v6, v6, v35
    s_waitcnt vmcnt(6)
    v_xor_b32 v36, s71, v36
    v_xor_b32 v37, s77, v37
    v_xor_b32 v38, s78, v38
L_w94:
    s_cbranch_execz L_w95
    v_xor_b32 v39, s79, v39
    v_or3_b32 v6, v6, v36, v37
    v_or3_b32 v6, v6, v38, v39
    s_waitcnt vmcnt(5)
    v_xor_b32 v40, s71, v40
    v_xor_b32 v41, s77, v41
    v_xor_b32 v42, s78, v42
    v_xor_b32 v43, s79, v43
    v_or3_b32 v6, v6, v40, v41
    v_or3_b32 v6, v6, v42, v43
L_w95:
    s_cbranch_execz L_w96
    s_waitcnt vmcnt(4)
    v_xor_b32 v44, s71, v44
    v_xor_b32 v45, s77, v45
    v_xor_b32 v46, s78, v46
    v_xor_b32 v47, s79, v47
    v_or3_b32 v6, v6, v44, v45
    v_or3_b32 v6, v6, v46, v47
    s_waitcnt vmcnt(3)
    v_xor_b32 v16, s71, v16
    v_xor_b32 v17, s77, v17
    v_xor_b32 v18, s78, v18
    v_xor_b32 v19, s79, v19
L_w96:
    s_cbranch_execz L_w97
    v_or3_b32 v6, v6, v16, v17
    v_or3_b32 v6, v6, v18, v19
    s_waitcnt vmcnt(2)
    v_xor_b32 v20, s71, v20
    v_xor_b32 v21, s77, v21
    v_xor_b32 v22, s78, v22
    v_xor_b32 v23, s79, v23
    v_or3_b32 v6, v6, v20, v21
    v_or3_b32 v6, v6, v22, v23
    s_waitcnt vmcnt(1)
L_w97:
    s_cbranch_execz L_w98
    v_xor_b32 v24, s71, v24
    v_xor_b32 v25, s77, v25
    v_xor_b32 v26, s78, v26
    v_xor_b32 v27, s79, v27
    v_or3_b32 v6, v6, v24, v25
    v_or3_b32 v6, v6, v26, v27
    s_waitcnt vmcnt(0)
    v_xor_b32 v28, s71, v28
    v_xor_b32 v29, s77, v29
    v_xor_b32 v30, s78, v30
    v_xor_b32 v31, s79, v31
L_w98:
    s_cbranch_execz L_w99
    v_or3_b32 v6, v6, v28, v29
    v_or3_b32 v6, v6, v30, v31
    v_and_b32 v6, 0xff, v6
    v_cmp_ne_u32 vcc, 0, v6
    s_xor_b32 s16, s16, s68
    s_xor_b32 s71, s71, s69
    s_cbranch_vccnz L_pl
L_pl_d:
    v_max3_f32 v48, v32, v36, v40
    v_max_f32 v48, v48, v44
    v_sub_f32 v49, v32, v48
L_w99:
    s_cbranch_execz L_w100
    v_sub_f32 v50, v36, v48
    v_sub_f32 v51, v40, v48
    v_sub_f32 v52, v44, v48
    v_exp_f32 v32, v49
    v_exp_f32 v34, v50
    v_exp_f32 v36, v51
    v_exp_f32 v38, v52
    v_add_f32 v48, v32, v34
    v_add_f32 v53, v36, v38
    v_add_f32 v48, v48, v53
    v_rcp_f32 v48, v48
    v_pk_mul_f32 v[60:61], v[16:17], v[32:33] op_sel_hi:[1,0]
L_w100:
    s_cbranch_execz L_w101
    v_pk_mul_f32 v[62:63], v[18:19], v[32:33] op_sel_hi:[1,0]
    v_pk_fma_f32 v[60:61], v[20:21], v[34:35], v[60:61] op_sel_hi:[1,0,1]
    v_pk_fma_f32 v[62:63], v[22:23], v[34:35], v[62:63] op_sel_hi:[1,0,1]
    v_pk_fma_f32 v[60:61], v[24:25], v[36:37], v[60:61] op_sel_hi:[1,0,1]
    v_pk_fma_f32 v[62:63], v[26:27], v[36:37], v[62:63] op_sel_hi:[1,0,1]
    v_pk_fma_f32 v[60:61], v[28:29], v[38:39], v[60:61] op_sel_hi:[1,0,1]
    v_pk_fma_f32 v[62:63], v[30:31], v[38:39], v[62:63] op_sel_hi:[1,0,1]
L_w101:
    s_cbranch_execz L_w102
    v_pk_mul_f32 v[60:61], v[60:61], v[48:49] op_sel_hi:[1,0]
    v_pk_mul_f32 v[62:63], v[62:63], v[48:49] op_sel_hi:[1,0]
    v_cvt_pk_bf16_f32 v60, v60, v61
    v_cvt_pk_bf16_f32 v61, v62, v63
    ds_write_b64 v56, v[60:61]
    s_waitcnt lgkmcnt(0)
    s_barrier
L_hop2:
    s_cmp_lt_u32 s73, 9
    s_cbranch_scc0 L_fin
L_w102:
    s_cbranch_execz L_w103
    s_mov_b32 s16, s72
L_sp_h2:
    s_sleep 20
    ds_read_b32 v6, v81 offset:8
    s_waitcnt lgkmcnt(0)
    v_readfirstlane_b32 s37, v6
    s_nop 0
    s_bfe_u32 s37, s37, 0x80018
    s_cmp_lt_u32 s37, 3
    s_cbranch_scc1 L_sp_h2
    s_mov_b32 s9, 2097151
L_pp:
L_w103:
    s_cbranch_execz L_w104
    buffer_load_dwordx4 v[16:19], v57, s[48:51], s16 offen sc1
    buffer_load_dwordx4 v[20:23], v57, s[48:51], s16 offen offset:1152 sc1
    buffer_load_dwordx4 v[24:27], v57, s[48:51], s16 offen offset:2304 sc1
    buffer_load_dwordx4 v[28:31], v57, s[48:51], s16 offen offset:3456 sc1
    s_sub_u32 s9, s9, 1
    s_cbranch_scc1 L_pp_d
    s_waitcnt vmcnt(3)
    v_xor_b32 v16, s3, v16
    v_xor_b32 v17, s77, v17
    v_xor_b32 v18, s78, v18
L_w104:
    s_cbranch_execz L_w105
    v_xor_b32 v19, s79, v19
    v_or3_b32 v6, v16, v17, v18
    v_or_b32 v6, v6, v19
    s_waitcnt vmcnt(2)
    v_xor_b32 v20, s3, v20
    v_xor_b32 v21, s77, v21
    v_xor_b32 v22, s78, v22
    v_xor_b32 v23, s79, v23
    v_or3_b32 v6, v6, v20, v21
    v_or3_b32 v6, v6, v22, v23
    s_waitcnt vmcnt(1)
L_w105:
    s_cbranch_execz L_w106
    v_xor_b32 v24, s3, v24
    v_xor_b32 v25, s77, v25
    v_xor_b32 v26, s78, v26
    v_xor_b32 v27, s79, v27
    v_or3_b32 v6, v6, v24, v25
    v_or3_b32 v6, v6, v26, v27
    s_waitcnt vmcnt(0)
    v_xor_b32 v28, s3, v28
    v_xor_b32 v29, s77, v29
    v_xor_b32 v30, s78, v30
    v_xor_b32 v31, s79, v31
L_w106:
    s_cbranch_execz L_w107
    v_or3_b32 v6, v6, v28, v29
    v_or3_b32 v6, v6, v30, v31
    v_and_b32 v6, 0xff, v6
    v_cmp_ne_u32 vcc, 0, v6
    s_cbranch_vccnz L_pp
L_pp_d:
    v_pk_add_f32 v[48:49], v[16:17], v[20:21]
    v_pk_add_f32 v[52:53], v[24:25], v[28:29]
    v_pk_add_f32 v[50:51], v[18:19], v[22:23]
L_w107:
    s_cbranch_execz L_w108
    v_pk_add_f32 v[54:55], v[26:27], v[30:31]
    v_pk_add_f32 v[48:49], v[48:49], v[52:53]
    v_pk_add_f32 v[50:51], v[50:51], v[54:55]
    s_nop 1
    v_permlane32_swap_b32 v48, v50
    v_permlane32_swap_b32 v49, v51
    v_add_f32 v48, v48, v50
    v_add_f32 v49, v49, v51
    s_nop 1
    v_permlane16_swap_b32 v48, v49
    v_add_f32 v48, v48, v49
L_w108:
    s_cbranch_execz L_w109
    s_nop 1
    v_add_f32_dpp v49, v48, v48 row_ror:8 row_mask:0xf bank_mask:0xf
    v_cvt_pk_bf16_f32 v49, v49, v49
    s_mov_b32 exec_lo, 0x00ff00ff
    s_mov_b32 exec_hi, 0x00ff00ff
    buffer_store_short v49, v58, s[64:67], 0 offen
    s_or_b32 s37, s33, s35
    s_xor_b32 s38, s36, 5
    s_or_b32 s37, s37, s38
    s_cmp_eq_u32 s37, 0
    s_cbranch_scc0 L_fin
    s_mov_b64 exec, 1
    v_mov_b32 v48, s39
    s_lshl_b32 s37, s32, 8
    v_mov_b32 v49, s37
    buffer_store_dword v48, v49, s[48:51], 0 offen
    s_branch L_fin
L_w109:
    s_mov_b64 exec, -1
    s_branch L_warmed
.section .rodata,"a"
.p2align 6
.amdhsa_kernel concat_heads__gqa_block_cached__gqa_block_cached__decode_kernel
  .amdhsa_next_free_vgpr 152
  .amdhsa_next_free_sgpr 102
  .amdhsa_accum_offset 152
  .amdhsa_group_segment_fixed_size 0
  .amdhsa_kernarg_size 104
  .amdhsa_user_sgpr_count 2
  .amdhsa_user_sgpr_kernarg_segment_ptr 1
  .amdhsa_system_sgpr_workgroup_id_x 1
.end_amdhsa_kernel
```
